```python
import torch

def _softmax(x, axis=-1):
    return torch.softmax(x, dim=axis)
def _gelu(x):
    return torch.nn.functional.gelu(x, approximate="tanh")
def _silu(x):
    return torch.nn.functional.silu(x)
def _sigmoid(x):
    return torch.sigmoid(x)
def _layernorm(x, axis=-1, eps=1e-5):
    m = x.mean(dim=axis, keepdim=True)
    v = x.var(dim=axis, keepdim=True, unbiased=False)
    return (x - m) / torch.sqrt(v + eps)
def _scatter_add(tgt, idx, src, axis=0):
    return tgt.clone().index_add_(axis, idx, src)
def _segment_sum(src, seg, n):
    out = torch.zeros((n,) + src.shape[1:], dtype=src.dtype)
    return out.index_add_(0, seg, src)
def _pad(x, pw):
    flat = tuple(v for pair in reversed(pw) for v in pair)
    return torch.nn.functional.pad(x, flat)

kernel_name = 'standalone__w4a16_gemm_dequant__prompt'

def setup_inputs():

    _w = (lambda a: (lambda t: t.to(torch.bfloat16) if t.is_floating_point() else t)(torch.as_tensor(a)))
    B, S, D, F = 1, 2048, 1024, 3584
    G = -1 if -1 > 0 else D
    D = (D // G) * G
    ng = D // G
    qw = torch.randint(0, 16, (D, F)).to(torch.int32)
    return {
        "x": _w((lambda *s: torch.randn(*s, dtype=torch.bfloat16) * 0.05)(B, S, D)),
        "qw": _w(qw),
        "scales": _w(torch.abs((lambda *s: torch.randn(*s, dtype=torch.bfloat16) * 0.05)(ng, F)) + 0.01),
        "zeros": _w(torch.full((ng, F), 8.0, dtype=float)),
    }

def reference(x, qw, scales, zeros):
    B, S, D = x.shape
    ng, F = scales.shape
    G = D // ng
    s = (lambda x, n, axis: torch.repeat_interleave(x, n, dim=axis))(scales, G, axis=0)
    z = (lambda x, n, axis: torch.repeat_interleave(x, n, dim=axis))(zeros, G, axis=0)
    w = ((lambda x, dt: x.to(dt))(qw, x.dtype) - z) * s
    return x @ w
```

```asm
; @launch grid=(256,1,1) block=(512,1,1) lds=160000
.amdgcn_target "amdgcn-amd-amdhsa--gfx950"
.text
.globl standalone__w4a16_gemm_dequant__prompt_kernel
.p2align 8
.type standalone__w4a16_gemm_dequant__prompt_kernel,@function
standalone__w4a16_gemm_dequant__prompt_kernel:
L_first:
s_cmp_ge_u32 s2, 256
s_cbranch_scc1 L_end
s_load_dwordx4 s[4:7], s[0:1], 0
s_load_dwordx2 s[8:9], s[0:1], 48
v_lshrrev_b32 v2, 6, v0
v_and_b32 v1, 63, v0
v_readfirstlane_b32 s14, v2
s_bfe_u32 s12, s2, 0x30003
s_and_b32 s15, s2, 1
s_lshl_b32 s15, s15, 3
s_or_b32 s12, s12, s15
s_bfe_u32 s13, s2, 0x20001
s_lshl_b32 s13, s13, 2
s_lshr_b32 s15, s2, 6
s_or_b32 s13, s13, s15
s_cmp_lg_u32 s14, 4
s_cbranch_scc1 L_nopf
s_getpc_b64 s[56:57]
L_pc:
s_mov_b32 s58, L_last - L_pc
s_mov_b32 s59, 0x00020000
s_bfe_u32 s28, s2, 0x30003
s_mul_i32 s28, s28, 2048
v_lshlrev_b32 v16, 4, v1
buffer_load_dwordx4 v[20:23], v16, s[56:59], s28 offen offset:0
buffer_load_dwordx4 v[20:23], v16, s[56:59], s28 offen offset:1024
L_nopf:
s_cmp_ge_u32 s14, 6
s_cbranch_scc1 L_rows0
s_cmp_lt_u32 s14, 1
s_cbranch_scc1 L_bi0
s_barrier
L_bi0:
s_cmp_ge_u32 s14, 4
s_cbranch_scc1 L_load
s_lshl_b32 s15, s14, 1
s_lshr_b32 s16, s12, 3
s_add_u32 s15, s15, s16
s_bfe_u32 s16, s12, 0x20001
s_and_b32 s17, s12, 1
s_lshl_b32 s18, s15, 3
s_add_u32 s18, s18, s16
s_mul_i32 s18, s18, 114688
s_mul_i32 s28, s13, 896
s_lshl_b32 s19, s17, 8
s_add_u32 s28, s28, s19
s_add_u32 s66, s18, s28
s_lshl_b32 s19, s17, 2
s_sub_u32 s19, 16, s19
v_lshrrev_b32 v3, 5, v1
v_and_b32 v5, 31, v1
v_mul_u32_u24 v4, 458752, v3
v_lshl_add_u32 v4, v5, 4, v4
v_and_b32 v9, 16, v1
v_mad_u32_u24 v4, v9, s19, v4
s_mov_b32 s34, 0x0fffffff
s_mov_b32 s35, 0x0fffffff
s_mov_b32 s70, 14680064
s_mov_b32 s71, 0x00020000
s_cmp_ge_u32 s14, 2
s_cbranch_scc1 L_zero_a
L_z0:
s_lshl_b32 s28, s13, 7
s_add_u32 s28, s28, 5275648
s_waitcnt lgkmcnt(0)
s_load_dword s36, s[8:9], s28
s_mov_b32 s68, s6
s_mov_b32 s69, s7
s_call_b64 s[72:73], L_uld
s_branch L_uld_end
L_uld:
s_mov_b64 exec, s[34:35]
buffer_load_dwordx4 v[128:131], v4, s[68:71], s66 offen
s_add_u32 s66, s66, 14336
buffer_load_dwordx4 v[132:135], v4, s[68:71], s66 offen
s_add_u32 s66, s66, 14336
buffer_load_dwordx4 v[136:139], v4, s[68:71], s66 offen
s_add_u32 s66, s66, 14336
buffer_load_dwordx4 v[140:143], v4, s[68:71], s66 offen
s_add_u32 s66, s66, 14336
buffer_load_dwordx4 v[144:147], v4, s[68:71], s66 offen
s_add_u32 s66, s66, 14336
buffer_load_dwordx4 v[148:151], v4, s[68:71], s66 offen
s_add_u32 s66, s66, 14336
buffer_load_dwordx4 v[152:155], v4, s[68:71], s66 offen
s_add_u32 s66, s66, 14336
buffer_load_dwordx4 v[156:159], v4, s[68:71], s66 offen
s_mov_b64 exec, -1
s_setpc_b64 s[72:73]
L_rows0:
s_lshl_b32 s28, s12, 7
s_lshl_b32 s29, s13, 3
s_add_u32 s28, s28, s29
s_lshl_b32 s29, s14, 2
s_add_u32 s28, s28, s29
s_sub_u32 s28, s28, 24
s_lshl_b32 s28, s28, 11
v_and_b32 v14, 15, v1
v_lshlrev_b32 v14, 4, v14
v_lshrrev_b32 v15, 4, v1
v_lshl_add_u32 v14, v15, 11, v14
s_mov_b32 s54, 4194304
s_mov_b32 s55, 0x00020000
s_waitcnt lgkmcnt(0)
s_mov_b32 s52, s4
s_mov_b32 s53, s5
s_barrier
buffer_load_dwordx4 v[16:19], v14, s[52:55], s28 offen offset:0
buffer_load_dwordx4 v[20:23], v14, s[52:55], s28 offen offset:256
buffer_load_dwordx4 v[24:27], v14, s[52:55], s28 offen offset:512
buffer_load_dwordx4 v[28:31], v14, s[52:55], s28 offen offset:768
s_branch L_load
L_uld_end:
s_cmp_ge_u32 s14, 1
s_cbranch_scc1 L_bi1
s_barrier
L_bi1:
s_mov_b32 s24, s8
s_and_b32 s25, s9, 0xffff
s_mov_b32 s26, 9961472
s_mov_b32 s27, 0x00020000
v_mul_u32_u24 v7, 448, v3
v_lshl_add_u32 v7, v5, 4, v7
s_lshl_b32 s28, s13, 4
s_add_u32 s28, s28, s15
s_mul_i32 s28, s28, 14336
s_mul_i32 s29, s17, 7168
s_add_u32 s28, s28, s29
s_mul_i32 s29, s16, 1792
s_add_u32 s28, s28, s29
s_add_u32 s67, s28, 1048576
s_mov_b32 s39, 0x0c0c0400
v_mov_b32 v15, 0x0f0f0f0f
s_and_b32 s15, s14, 1
s_lshr_b32 s16, s14, 1
v_and_b32 v3, 15, v1
v_lshrrev_b32 v4, 4, v1
v_lshrrev_b32 v9, 1, v3
v_xor_b32 v9, v9, v4
v_lshlrev_b32 v9, 4, v9
s_lshl_b32 s17, s15, 6
v_add_u32 v8, s17, v3
v_lshl_add_u32 v240, v8, 7, v9
v_xor_b32 v241, 64, v240
v_mul_u32_u24 v5, 272, v8
v_lshl_add_u32 v5, v4, 3, v5
s_lshl_b32 s17, s16, 7
s_add_u32 s17, s17, 125184
v_add_u32 v5, s17, v5
v_mul_u32_u24 v13, 208, v8
v_lshl_add_u32 v13, v4, 3, v13
s_mul_i32 s17, s16, 96
v_add_u32 v13, s17, v13
v_and_b32 v8, 1, v3
v_bfe_u32 v9, v3, 1, 1
v_lshl_or_b32 v8, v8, 1, v9
v_mul_u32_u24 v8, 448, v8
v_mul_u32_u24 v9, 1792, v4
v_add_u32 v8, v8, v9
v_lshrrev_b32 v9, 2, v3
v_lshl_add_u32 v8, v9, 4, v8
s_mul_i32 s17, s16, 7168
s_add_u32 s17, s17, 16384
v_add_u32 v242, s17, v8
s_lshl_b32 s17, s15, 8
s_add_u32 s17, s17, 122880
v_lshlrev_b32 v8, 4, v3
v_add_u32 v8, s17, v8
s_mul_i32 s17, s16, 448
s_add_u32 s17, s17, 123392
v_lshlrev_b32 v6, 4, v4
v_add_u32 v6, s17, v6
s_mov_b32 s30, 0x04010400
s_mov_b32 s31, 0x04030402
v_mov_b32 v10, v240
v_mov_b32 v11, v241
v_mov_b32 v12, v242
s_mov_b32 s32, 0
s_mov_b32 s33, 0
s_cmp_ge_u32 s14, 2
s_cbranch_scc1 L_z1
L_zero_a:
v_mov_b64 v[16:17], 0
v_mov_b64 v[18:19], 0
v_mov_b64 v[20:21], 0
v_mov_b64 v[22:23], 0
v_mov_b64 v[24:25], 0
v_mov_b64 v[26:27], 0
v_mov_b64 v[28:29], 0
v_mov_b64 v[30:31], 0
v_mov_b64 v[32:33], 0
v_mov_b64 v[34:35], 0
v_mov_b64 v[36:37], 0
v_mov_b64 v[38:39], 0
v_mov_b64 v[40:41], 0
v_mov_b64 v[42:43], 0
v_mov_b64 v[44:45], 0
v_mov_b64 v[46:47], 0
v_mov_b64 v[48:49], 0
v_mov_b64 v[50:51], 0
v_mov_b64 v[52:53], 0
v_mov_b64 v[54:55], 0
v_mov_b64 v[56:57], 0
v_mov_b64 v[58:59], 0
v_mov_b64 v[60:61], 0
v_mov_b64 v[62:63], 0
v_mov_b64 v[64:65], 0
v_mov_b64 v[66:67], 0
v_mov_b64 v[68:69], 0
v_mov_b64 v[70:71], 0
v_mov_b64 v[72:73], 0
v_mov_b64 v[74:75], 0
v_mov_b64 v[76:77], 0
v_mov_b64 v[78:79], 0
v_mov_b64 v[80:81], 0
v_mov_b64 v[82:83], 0
v_mov_b64 v[84:85], 0
v_mov_b64 v[86:87], 0
v_mov_b64 v[88:89], 0
v_mov_b64 v[90:91], 0
v_mov_b64 v[92:93], 0
v_mov_b64 v[94:95], 0
v_mov_b64 v[96:97], 0
v_mov_b64 v[98:99], 0
v_mov_b64 v[100:101], 0
v_mov_b64 v[102:103], 0
v_mov_b64 v[104:105], 0
v_mov_b64 v[106:107], 0
v_mov_b64 v[108:109], 0
v_mov_b64 v[110:111], 0
v_mov_b64 v[112:113], 0
v_mov_b64 v[114:115], 0
v_mov_b64 v[116:117], 0
v_mov_b64 v[118:119], 0
v_mov_b64 v[120:121], 0
v_mov_b64 v[122:123], 0
v_mov_b64 v[124:125], 0
v_mov_b64 v[126:127], 0
s_cmp_ge_u32 s14, 2
s_cbranch_scc1 L_z0
L_z1:
s_waitcnt lgkmcnt(0)
s_bfe_u32 s36, s36, 0x10007
s_xor_b32 s36, s36, 1
s_mul_i32 s38, s36, 0x80808080
s_mul_i32 s28, s36, 0x01010101
s_sub_u32 s28, 0x43434343, s28
v_mov_b32 v2, s28
s_cmp_lt_u32 s14, 2
s_cbranch_scc1 L_pub0
s_waitcnt vmcnt(0)
s_barrier
L_pub0:
s_waitcnt vmcnt(4)
s_call_b64 s[72:73], L_pk0
s_waitcnt vmcnt(0)
s_call_b64 s[72:73], L_pk1
s_branch L_pk_end
L_pk0:
v_perm_b32 v168, v132, v128, s39
v_perm_b32 v169, v133, v129, s39
v_perm_b32 v170, v134, v130, s39
v_perm_b32 v171, v135, v131, s39
v_perm_b32 v172, v140, v136, s39
v_perm_b32 v173, v141, v137, s39
v_perm_b32 v174, v142, v138, s39
v_perm_b32 v175, v143, v139, s39
v_lshl_or_b32 v168, v172, 16, v168
v_lshl_or_b32 v169, v173, 16, v169
v_lshl_or_b32 v170, v174, 16, v170
v_lshl_or_b32 v171, v175, 16, v171
v_and_or_b32 v160, v168, v15, s38
v_and_or_b32 v164, v169, v15, s38
v_and_or_b32 v162, v170, v15, s38
v_and_or_b32 v166, v171, v15, s38
s_setpc_b64 s[72:73]
L_pk1:
v_perm_b32 v168, v148, v144, s39
v_perm_b32 v169, v149, v145, s39
v_perm_b32 v170, v150, v146, s39
v_perm_b32 v171, v151, v147, s39
v_perm_b32 v172, v156, v152, s39
v_perm_b32 v173, v157, v153, s39
v_perm_b32 v174, v158, v154, s39
v_perm_b32 v175, v159, v155, s39
v_lshl_or_b32 v168, v172, 16, v168
v_lshl_or_b32 v169, v173, 16, v169
v_lshl_or_b32 v170, v174, 16, v170
v_lshl_or_b32 v171, v175, 16, v171
v_and_or_b32 v161, v168, v15, s38
v_and_or_b32 v165, v169, v15, s38
v_and_or_b32 v163, v170, v15, s38
v_and_or_b32 v167, v171, v15, s38
s_nop 1
v_permlane32_swap_b32 v160, v162
v_permlane32_swap_b32 v164, v166
v_permlane32_swap_b32 v161, v163
v_permlane32_swap_b32 v165, v167
s_mov_b64 exec, s[34:35]
buffer_store_dwordx4 v[160:163], v7, s[24:27], s67 offen sc1
buffer_store_dwordx4 v[164:167], v7, s[24:27], s67 offen offset:896 sc1
s_mov_b64 exec, -1
s_setpc_b64 s[72:73]
L_pk_end:
s_cmp_ge_u32 s14, 2
s_cbranch_scc1 L_pub1
s_barrier
L_pub1:
s_branch L_pad0
.p2align 12
L_pad0:
s_barrier
L_mm:
ds_read_b128 v[192:195], v12
ds_read_b128 v[128:131], v10 offset:0
ds_read_b128 v[144:147], v11 offset:0
ds_read_b128 v[132:135], v10 offset:2048
ds_read_b128 v[148:151], v11 offset:2048
ds_read_b128 v[136:139], v10 offset:4096
ds_read_b128 v[152:155], v11 offset:4096
ds_read_b128 v[140:143], v10 offset:6144
ds_read_b128 v[156:159], v11 offset:6144
ds_read_b128 v[196:199], v12 offset:64
ds_read_b128 v[200:203], v12 offset:128
s_waitcnt lgkmcnt(10)
v_perm_b32 v220, v2, v192, s30
v_perm_b32 v221, v2, v192, s31
v_perm_b32 v222, v2, v193, s30
v_perm_b32 v223, v2, v193, s31
v_perm_b32 v224, v2, v194, s30
v_perm_b32 v225, v2, v194, s31
v_perm_b32 v226, v2, v195, s30
v_perm_b32 v227, v2, v195, s31
s_waitcnt lgkmcnt(0)
s_branch L_loop
.p2align 6
L_loop:
v_mfma_f32_16x16x32_bf16 v[16:19], v[220:223], v[128:131], v[16:19]
s_waitcnt lgkmcnt(1)
v_perm_b32 v228, v2, v196, s30
v_mfma_f32_16x16x32_bf16 v[16:19], v[224:227], v[144:147], v[16:19]
v_perm_b32 v229, v2, v196, s31
v_perm_b32 v230, v2, v197, s30
v_mfma_f32_16x16x32_bf16 v[20:23], v[224:227], v[148:151], v[20:23]
ds_read_b128 v[204:207], v12 offset:192
v_perm_b32 v231, v2, v197, s31
v_mfma_f32_16x16x32_bf16 v[20:23], v[220:223], v[132:135], v[20:23]
v_perm_b32 v232, v2, v198, s30
v_mfma_f32_16x16x32_bf16 v[24:27], v[220:223], v[136:139], v[24:27]
ds_read_b128 v[208:211], v12 offset:256
v_perm_b32 v233, v2, v198, s31
v_mfma_f32_16x16x32_bf16 v[24:27], v[224:227], v[152:155], v[24:27]
v_perm_b32 v234, v2, v199, s30
v_mfma_f32_16x16x32_bf16 v[28:31], v[224:227], v[156:159], v[28:31]
ds_read_b128 v[212:215], v12 offset:320
v_perm_b32 v235, v2, v199, s31
v_mfma_f32_16x16x32_bf16 v[28:31], v[220:223], v[140:143], v[28:31]
s_waitcnt lgkmcnt(3)
v_perm_b32 v220, v2, v200, s30
v_mfma_f32_16x16x32_bf16 v[32:35], v[228:231], v[128:131], v[32:35]
v_perm_b32 v221, v2, v200, s31
v_mfma_f32_16x16x32_bf16 v[32:35], v[232:235], v[144:147], v[32:35]
ds_read_b128 v[216:219], v12 offset:384
v_perm_b32 v222, v2, v201, s30
v_mfma_f32_16x16x32_bf16 v[36:39], v[232:235], v[148:151], v[36:39]
s_add_u32 s32, s32, 30720
v_perm_b32 v223, v2, v201, s31
v_mfma_f32_16x16x32_bf16 v[36:39], v[228:231], v[132:135], v[36:39]
s_cmp_eq_u32 s32, 122880
v_perm_b32 v224, v2, v202, s30
v_mfma_f32_16x16x32_bf16 v[40:43], v[228:231], v[136:139], v[40:43]
s_cselect_b32 s32, 0, s32
v_perm_b32 v225, v2, v202, s31
v_mfma_f32_16x16x32_bf16 v[40:43], v[232:235], v[152:155], v[40:43]
v_perm_b32 v226, v2, v203, s30
v_mfma_f32_16x16x32_bf16 v[44:47], v[232:235], v[156:159], v[44:47]
v_perm_b32 v227, v2, v203, s31
v_mfma_f32_16x16x32_bf16 v[44:47], v[228:231], v[140:143], v[44:47]
s_waitcnt lgkmcnt(3)
v_perm_b32 v228, v2, v204, s30
v_mfma_f32_16x16x32_bf16 v[48:51], v[220:223], v[128:131], v[48:51]
v_add_u32 v10, s32, v240
v_perm_b32 v229, v2, v204, s31
v_mfma_f32_16x16x32_bf16 v[48:51], v[224:227], v[144:147], v[48:51]
v_add_u32 v11, s32, v241
v_perm_b32 v230, v2, v205, s30
v_mfma_f32_16x16x32_bf16 v[52:55], v[224:227], v[148:151], v[52:55]
v_perm_b32 v231, v2, v205, s31
v_mfma_f32_16x16x32_bf16 v[52:55], v[220:223], v[132:135], v[52:55]
v_perm_b32 v232, v2, v206, s30
v_mfma_f32_16x16x32_bf16 v[56:59], v[220:223], v[136:139], v[56:59]
v_perm_b32 v233, v2, v206, s31
v_mfma_f32_16x16x32_bf16 v[56:59], v[224:227], v[152:155], v[56:59]
v_perm_b32 v234, v2, v207, s30
v_mfma_f32_16x16x32_bf16 v[60:63], v[224:227], v[156:159], v[60:63]
v_perm_b32 v235, v2, v207, s31
v_mfma_f32_16x16x32_bf16 v[60:63], v[220:223], v[140:143], v[60:63]
s_waitcnt lgkmcnt(0)
v_perm_b32 v220, v2, v208, s30
v_mfma_f32_16x16x32_bf16 v[64:67], v[228:231], v[128:131], v[64:67]
s_barrier
v_perm_b32 v221, v2, v208, s31
v_mfma_f32_16x16x32_bf16 v[64:67], v[232:235], v[144:147], v[64:67]
v_perm_b32 v222, v2, v209, s30
v_mfma_f32_16x16x32_bf16 v[68:71], v[232:235], v[148:151], v[68:71]
ds_read_b128 v[160:163], v10 offset:0
v_perm_b32 v223, v2, v209, s31
v_mfma_f32_16x16x32_bf16 v[68:71], v[228:231], v[132:135], v[68:71]
v_perm_b32 v224, v2, v210, s30
v_mfma_f32_16x16x32_bf16 v[72:75], v[228:231], v[136:139], v[72:75]
v_perm_b32 v225, v2, v210, s31
v_mfma_f32_16x16x32_bf16 v[72:75], v[232:235], v[152:155], v[72:75]
v_perm_b32 v226, v2, v211, s30
v_mfma_f32_16x16x32_bf16 v[76:79], v[232:235], v[156:159], v[76:79]
ds_read_b128 v[176:179], v11 offset:0
v_perm_b32 v227, v2, v211, s31
v_mfma_f32_16x16x32_bf16 v[76:79], v[228:231], v[140:143], v[76:79]
v_perm_b32 v228, v2, v212, s30
v_mfma_f32_16x16x32_bf16 v[80:83], v[220:223], v[128:131], v[80:83]
ds_read_b128 v[164:167], v10 offset:2048
v_perm_b32 v229, v2, v212, s31
v_mfma_f32_16x16x32_bf16 v[80:83], v[224:227], v[144:147], v[80:83]
v_add_u32 v12, s32, v242
v_perm_b32 v230, v2, v213, s30
v_mfma_f32_16x16x32_bf16 v[84:87], v[224:227], v[148:151], v[84:87]
ds_read_b128 v[180:183], v11 offset:2048
v_perm_b32 v231, v2, v213, s31
v_mfma_f32_16x16x32_bf16 v[84:87], v[220:223], v[132:135], v[84:87]
v_perm_b32 v232, v2, v214, s30
v_mfma_f32_16x16x32_bf16 v[88:91], v[220:223], v[136:139], v[88:91]
ds_read_b128 v[192:195], v12 offset:0
v_perm_b32 v233, v2, v214, s31
v_mfma_f32_16x16x32_bf16 v[88:91], v[224:227], v[152:155], v[88:91]
v_perm_b32 v234, v2, v215, s30
v_mfma_f32_16x16x32_bf16 v[92:95], v[224:227], v[156:159], v[92:95]
ds_read_b128 v[168:171], v10 offset:4096
v_perm_b32 v235, v2, v215, s31
v_mfma_f32_16x16x32_bf16 v[92:95], v[220:223], v[140:143], v[92:95]
v_perm_b32 v220, v2, v216, s30
v_mfma_f32_16x16x32_bf16 v[96:99], v[228:231], v[128:131], v[96:99]
ds_read_b128 v[184:187], v11 offset:4096
v_perm_b32 v221, v2, v216, s31
v_mfma_f32_16x16x32_bf16 v[96:99], v[232:235], v[144:147], v[96:99]
ds_read_b128 v[172:175], v10 offset:6144
v_perm_b32 v222, v2, v217, s30
v_mfma_f32_16x16x32_bf16 v[100:103], v[232:235], v[148:151], v[100:103]
ds_read_b128 v[188:191], v11 offset:6144
v_perm_b32 v223, v2, v217, s31
v_mfma_f32_16x16x32_bf16 v[100:103], v[228:231], v[132:135], v[100:103]
v_perm_b32 v224, v2, v218, s30
v_mfma_f32_16x16x32_bf16 v[104:107], v[228:231], v[136:139], v[104:107]
ds_read_b128 v[196:199], v12 offset:64
v_perm_b32 v225, v2, v218, s31
v_mfma_f32_16x16x32_bf16 v[104:107], v[232:235], v[152:155], v[104:107]
v_perm_b32 v226, v2, v219, s30
v_mfma_f32_16x16x32_bf16 v[108:111], v[232:235], v[156:159], v[108:111]
v_perm_b32 v227, v2, v219, s31
v_mfma_f32_16x16x32_bf16 v[108:111], v[228:231], v[140:143], v[108:111]
s_waitcnt lgkmcnt(5)
v_perm_b32 v228, v2, v192, s30
v_mfma_f32_16x16x32_bf16 v[112:115], v[220:223], v[128:131], v[112:115]
v_perm_b32 v229, v2, v192, s31
v_mfma_f32_16x16x32_bf16 v[112:115], v[224:227], v[144:147], v[112:115]
v_perm_b32 v230, v2, v193, s30
v_mfma_f32_16x16x32_bf16 v[116:119], v[224:227], v[148:151], v[116:119]
v_perm_b32 v231, v2, v193, s31
v_mfma_f32_16x16x32_bf16 v[116:119], v[220:223], v[132:135], v[116:119]
v_perm_b32 v232, v2, v194, s30
v_mfma_f32_16x16x32_bf16 v[120:123], v[220:223], v[136:139], v[120:123]
ds_read_b128 v[200:203], v12 offset:128
v_perm_b32 v233, v2, v194, s31
v_mfma_f32_16x16x32_bf16 v[120:123], v[224:227], v[152:155], v[120:123]
v_perm_b32 v234, v2, v195, s30
v_mfma_f32_16x16x32_bf16 v[124:127], v[224:227], v[156:159], v[124:127]
v_perm_b32 v235, v2, v195, s31
v_mfma_f32_16x16x32_bf16 v[124:127], v[220:223], v[140:143], v[124:127]
v_mfma_f32_16x16x32_bf16 v[16:19], v[228:231], v[160:163], v[16:19]
s_waitcnt lgkmcnt(1)
v_perm_b32 v220, v2, v196, s30
v_mfma_f32_16x16x32_bf16 v[16:19], v[232:235], v[176:179], v[16:19]
v_perm_b32 v221, v2, v196, s31
v_perm_b32 v222, v2, v197, s30
v_mfma_f32_16x16x32_bf16 v[20:23], v[232:235], v[180:183], v[20:23]
ds_read_b128 v[204:207], v12 offset:192
v_perm_b32 v223, v2, v197, s31
v_mfma_f32_16x16x32_bf16 v[20:23], v[228:231], v[164:167], v[20:23]
v_perm_b32 v224, v2, v198, s30
v_mfma_f32_16x16x32_bf16 v[24:27], v[228:231], v[168:171], v[24:27]
ds_read_b128 v[208:211], v12 offset:256
v_perm_b32 v225, v2, v198, s31
v_mfma_f32_16x16x32_bf16 v[24:27], v[232:235], v[184:187], v[24:27]
v_perm_b32 v226, v2, v199, s30
v_mfma_f32_16x16x32_bf16 v[28:31], v[232:235], v[188:191], v[28:31]
ds_read_b128 v[212:215], v12 offset:320
v_perm_b32 v227, v2, v199, s31
v_mfma_f32_16x16x32_bf16 v[28:31], v[228:231], v[172:175], v[28:31]
s_waitcnt lgkmcnt(3)
v_perm_b32 v228, v2, v200, s30
v_mfma_f32_16x16x32_bf16 v[32:35], v[220:223], v[160:163], v[32:35]
v_perm_b32 v229, v2, v200, s31
v_mfma_f32_16x16x32_bf16 v[32:35], v[224:227], v[176:179], v[32:35]
ds_read_b128 v[216:219], v12 offset:384
v_perm_b32 v230, v2, v201, s30
v_mfma_f32_16x16x32_bf16 v[36:39], v[224:227], v[180:183], v[36:39]
s_add_u32 s32, s32, 30720
v_perm_b32 v231, v2, v201, s31
v_mfma_f32_16x16x32_bf16 v[36:39], v[220:223], v[164:167], v[36:39]
s_cmp_eq_u32 s32, 122880
v_perm_b32 v232, v2, v202, s30
v_mfma_f32_16x16x32_bf16 v[40:43], v[220:223], v[168:171], v[40:43]
s_cselect_b32 s32, 0, s32
v_perm_b32 v233, v2, v202, s31
v_mfma_f32_16x16x32_bf16 v[40:43], v[224:227], v[184:187], v[40:43]
v_perm_b32 v234, v2, v203, s30
v_mfma_f32_16x16x32_bf16 v[44:47], v[224:227], v[188:191], v[44:47]
v_perm_b32 v235, v2, v203, s31
v_mfma_f32_16x16x32_bf16 v[44:47], v[220:223], v[172:175], v[44:47]
s_waitcnt lgkmcnt(3)
v_perm_b32 v220, v2, v204, s30
v_mfma_f32_16x16x32_bf16 v[48:51], v[228:231], v[160:163], v[48:51]
v_add_u32 v10, s32, v240
v_perm_b32 v221, v2, v204, s31
v_mfma_f32_16x16x32_bf16 v[48:51], v[232:235], v[176:179], v[48:51]
v_add_u32 v11, s32, v241
v_perm_b32 v222, v2, v205, s30
v_mfma_f32_16x16x32_bf16 v[52:55], v[232:235], v[180:183], v[52:55]
v_perm_b32 v223, v2, v205, s31
v_mfma_f32_16x16x32_bf16 v[52:55], v[228:231], v[164:167], v[52:55]
v_perm_b32 v224, v2, v206, s30
v_mfma_f32_16x16x32_bf16 v[56:59], v[228:231], v[168:171], v[56:59]
v_perm_b32 v225, v2, v206, s31
v_mfma_f32_16x16x32_bf16 v[56:59], v[232:235], v[184:187], v[56:59]
v_perm_b32 v226, v2, v207, s30
v_mfma_f32_16x16x32_bf16 v[60:63], v[232:235], v[188:191], v[60:63]
v_perm_b32 v227, v2, v207, s31
v_mfma_f32_16x16x32_bf16 v[60:63], v[228:231], v[172:175], v[60:63]
s_waitcnt lgkmcnt(0)
v_perm_b32 v228, v2, v208, s30
v_mfma_f32_16x16x32_bf16 v[64:67], v[220:223], v[160:163], v[64:67]
s_barrier
v_perm_b32 v229, v2, v208, s31
v_mfma_f32_16x16x32_bf16 v[64:67], v[224:227], v[176:179], v[64:67]
v_perm_b32 v230, v2, v209, s30
v_mfma_f32_16x16x32_bf16 v[68:71], v[224:227], v[180:183], v[68:71]
ds_read_b128 v[128:131], v10 offset:0
v_perm_b32 v231, v2, v209, s31
v_mfma_f32_16x16x32_bf16 v[68:71], v[220:223], v[164:167], v[68:71]
v_perm_b32 v232, v2, v210, s30
v_mfma_f32_16x16x32_bf16 v[72:75], v[220:223], v[168:171], v[72:75]
v_perm_b32 v233, v2, v210, s31
v_mfma_f32_16x16x32_bf16 v[72:75], v[224:227], v[184:187], v[72:75]
v_perm_b32 v234, v2, v211, s30
v_mfma_f32_16x16x32_bf16 v[76:79], v[224:227], v[188:191], v[76:79]
ds_read_b128 v[144:147], v11 offset:0
v_perm_b32 v235, v2, v211, s31
v_mfma_f32_16x16x32_bf16 v[76:79], v[220:223], v[172:175], v[76:79]
v_perm_b32 v220, v2, v212, s30
v_mfma_f32_16x16x32_bf16 v[80:83], v[228:231], v[160:163], v[80:83]
ds_read_b128 v[132:135], v10 offset:2048
v_perm_b32 v221, v2, v212, s31
v_mfma_f32_16x16x32_bf16 v[80:83], v[232:235], v[176:179], v[80:83]
v_add_u32 v12, s32, v242
v_perm_b32 v222, v2, v213, s30
v_mfma_f32_16x16x32_bf16 v[84:87], v[232:235], v[180:183], v[84:87]
ds_read_b128 v[148:151], v11 offset:2048
v_perm_b32 v223, v2, v213, s31
v_mfma_f32_16x16x32_bf16 v[84:87], v[228:231], v[164:167], v[84:87]
v_perm_b32 v224, v2, v214, s30
v_mfma_f32_16x16x32_bf16 v[88:91], v[228:231], v[168:171], v[88:91]
ds_read_b128 v[192:195], v12 offset:0
v_perm_b32 v225, v2, v214, s31
v_mfma_f32_16x16x32_bf16 v[88:91], v[232:235], v[184:187], v[88:91]
v_perm_b32 v226, v2, v215, s30
v_mfma_f32_16x16x32_bf16 v[92:95], v[232:235], v[188:191], v[92:95]
ds_read_b128 v[136:139], v10 offset:4096
v_perm_b32 v227, v2, v215, s31
v_mfma_f32_16x16x32_bf16 v[92:95], v[228:231], v[172:175], v[92:95]
v_perm_b32 v228, v2, v216, s30
v_mfma_f32_16x16x32_bf16 v[96:99], v[220:223], v[160:163], v[96:99]
ds_read_b128 v[152:155], v11 offset:4096
v_perm_b32 v229, v2, v216, s31
v_mfma_f32_16x16x32_bf16 v[96:99], v[224:227], v[176:179], v[96:99]
ds_read_b128 v[140:143], v10 offset:6144
v_perm_b32 v230, v2, v217, s30
v_mfma_f32_16x16x32_bf16 v[100:103], v[224:227], v[180:183], v[100:103]
ds_read_b128 v[156:159], v11 offset:6144
v_perm_b32 v231, v2, v217, s31
v_mfma_f32_16x16x32_bf16 v[100:103], v[220:223], v[164:167], v[100:103]
v_perm_b32 v232, v2, v218, s30
v_mfma_f32_16x16x32_bf16 v[104:107], v[220:223], v[168:171], v[104:107]
ds_read_b128 v[196:199], v12 offset:64
v_perm_b32 v233, v2, v218, s31
v_mfma_f32_16x16x32_bf16 v[104:107], v[224:227], v[184:187], v[104:107]
v_perm_b32 v234, v2, v219, s30
v_mfma_f32_16x16x32_bf16 v[108:111], v[224:227], v[188:191], v[108:111]
v_perm_b32 v235, v2, v219, s31
v_mfma_f32_16x16x32_bf16 v[108:111], v[220:223], v[172:175], v[108:111]
s_waitcnt lgkmcnt(5)
v_perm_b32 v220, v2, v192, s30
v_mfma_f32_16x16x32_bf16 v[112:115], v[228:231], v[160:163], v[112:115]
s_add_u32 s33, s33, 1
v_perm_b32 v221, v2, v192, s31
v_mfma_f32_16x16x32_bf16 v[112:115], v[232:235], v[176:179], v[112:115]
v_perm_b32 v222, v2, v193, s30
v_mfma_f32_16x16x32_bf16 v[116:119], v[232:235], v[180:183], v[116:119]
s_cmp_lt_u32 s33, 6
v_perm_b32 v223, v2, v193, s31
v_mfma_f32_16x16x32_bf16 v[116:119], v[228:231], v[164:167], v[116:119]
v_perm_b32 v224, v2, v194, s30
v_mfma_f32_16x16x32_bf16 v[120:123], v[228:231], v[168:171], v[120:123]
ds_read_b128 v[200:203], v12 offset:128
v_perm_b32 v225, v2, v194, s31
v_mfma_f32_16x16x32_bf16 v[120:123], v[232:235], v[184:187], v[120:123]
v_perm_b32 v226, v2, v195, s30
v_mfma_f32_16x16x32_bf16 v[124:127], v[232:235], v[188:191], v[124:127]
v_perm_b32 v227, v2, v195, s31
v_mfma_f32_16x16x32_bf16 v[124:127], v[228:231], v[172:175], v[124:127]
s_cbranch_scc1 L_loop
L_tail:
v_mfma_f32_16x16x32_bf16 v[16:19], v[220:223], v[128:131], v[16:19]
s_waitcnt lgkmcnt(1)
v_perm_b32 v228, v2, v196, s30
v_mfma_f32_16x16x32_bf16 v[16:19], v[224:227], v[144:147], v[16:19]
v_perm_b32 v229, v2, v196, s31
v_perm_b32 v230, v2, v197, s30
v_mfma_f32_16x16x32_bf16 v[20:23], v[224:227], v[148:151], v[20:23]
v_add_u32 v10, 61440, v240
v_perm_b32 v231, v2, v197, s31
v_mfma_f32_16x16x32_bf16 v[20:23], v[220:223], v[132:135], v[20:23]
v_add_u32 v11, 61440, v241
v_perm_b32 v232, v2, v198, s30
v_mfma_f32_16x16x32_bf16 v[24:27], v[220:223], v[136:139], v[24:27]
ds_read_b128 v[204:207], v242 offset:192
v_perm_b32 v233, v2, v198, s31
v_mfma_f32_16x16x32_bf16 v[24:27], v[224:227], v[152:155], v[24:27]
v_add_u32 v12, 61440, v242
v_perm_b32 v234, v2, v199, s30
v_mfma_f32_16x16x32_bf16 v[28:31], v[224:227], v[156:159], v[28:31]
v_perm_b32 v235, v2, v199, s31
v_mfma_f32_16x16x32_bf16 v[28:31], v[220:223], v[140:143], v[28:31]
s_waitcnt lgkmcnt(1)
v_perm_b32 v220, v2, v200, s30
v_mfma_f32_16x16x32_bf16 v[32:35], v[228:231], v[128:131], v[32:35]
s_barrier
v_perm_b32 v221, v2, v200, s31
v_mfma_f32_16x16x32_bf16 v[32:35], v[232:235], v[144:147], v[32:35]
ds_read_b128 v[160:163], v240 offset:30720
v_perm_b32 v222, v2, v201, s30
v_mfma_f32_16x16x32_bf16 v[36:39], v[232:235], v[148:151], v[36:39]
ds_read_b128 v[176:179], v241 offset:30720
v_perm_b32 v223, v2, v201, s31
v_mfma_f32_16x16x32_bf16 v[36:39], v[228:231], v[132:135], v[36:39]
ds_read_b128 v[164:167], v240 offset:32768
v_perm_b32 v224, v2, v202, s30
v_mfma_f32_16x16x32_bf16 v[40:43], v[228:231], v[136:139], v[40:43]
ds_read_b128 v[192:195], v242 offset:30720
v_perm_b32 v225, v2, v202, s31
v_mfma_f32_16x16x32_bf16 v[40:43], v[232:235], v[152:155], v[40:43]
ds_read_b128 v[180:183], v241 offset:32768
v_perm_b32 v226, v2, v203, s30
v_mfma_f32_16x16x32_bf16 v[44:47], v[232:235], v[156:159], v[44:47]
ds_read_b128 v[168:171], v240 offset:34816
v_perm_b32 v227, v2, v203, s31
v_mfma_f32_16x16x32_bf16 v[44:47], v[228:231], v[140:143], v[44:47]
s_waitcnt lgkmcnt(6)
v_perm_b32 v228, v2, v204, s30
v_mfma_f32_16x16x32_bf16 v[48:51], v[220:223], v[128:131], v[48:51]
ds_read_b128 v[184:187], v241 offset:34816
v_perm_b32 v229, v2, v204, s31
v_mfma_f32_16x16x32_bf16 v[48:51], v[224:227], v[144:147], v[48:51]
ds_read_b128 v[172:175], v240 offset:36864
v_perm_b32 v230, v2, v205, s30
v_mfma_f32_16x16x32_bf16 v[52:55], v[224:227], v[148:151], v[52:55]
ds_read_b128 v[188:191], v241 offset:36864
v_perm_b32 v231, v2, v205, s31
v_mfma_f32_16x16x32_bf16 v[52:55], v[220:223], v[132:135], v[52:55]
ds_read_b128 v[244:247], v8
v_perm_b32 v232, v2, v206, s30
v_mfma_f32_16x16x32_bf16 v[56:59], v[220:223], v[136:139], v[56:59]
ds_read_b128 v[196:199], v242 offset:30784
v_perm_b32 v233, v2, v206, s31
v_mfma_f32_16x16x32_bf16 v[56:59], v[224:227], v[152:155], v[56:59]
ds_read_b128 v[248:251], v6 offset:896
v_perm_b32 v234, v2, v207, s30
v_mfma_f32_16x16x32_bf16 v[60:63], v[224:227], v[156:159], v[60:63]
ds_read_b128 v[208:211], v6 offset:960
v_perm_b32 v235, v2, v207, s31
v_mfma_f32_16x16x32_bf16 v[60:63], v[220:223], v[140:143], v[60:63]
s_waitcnt lgkmcnt(9)
v_perm_b32 v220, v2, v192, s30
v_mfma_f32_16x16x32_bf16 v[64:67], v[228:231], v[128:131], v[64:67]
ds_read_b128 v[212:215], v6 offset:1024
v_perm_b32 v221, v2, v192, s31
v_mfma_f32_16x16x32_bf16 v[64:67], v[232:235], v[144:147], v[64:67]
ds_read_b128 v[216:219], v6 offset:1088
v_perm_b32 v222, v2, v193, s30
v_mfma_f32_16x16x32_bf16 v[68:71], v[232:235], v[148:151], v[68:71]
v_perm_b32 v223, v2, v193, s31
v_mfma_f32_16x16x32_bf16 v[68:71], v[228:231], v[132:135], v[68:71]
v_perm_b32 v224, v2, v194, s30
v_mfma_f32_16x16x32_bf16 v[72:75], v[228:231], v[136:139], v[72:75]
ds_read_b128 v[200:203], v242 offset:30848
v_perm_b32 v225, v2, v194, s31
v_mfma_f32_16x16x32_bf16 v[72:75], v[232:235], v[152:155], v[72:75]
v_perm_b32 v226, v2, v195, s30
v_mfma_f32_16x16x32_bf16 v[76:79], v[232:235], v[156:159], v[76:79]
v_perm_b32 v227, v2, v195, s31
v_mfma_f32_16x16x32_bf16 v[76:79], v[228:231], v[140:143], v[76:79]
s_waitcnt lgkmcnt(5)
v_perm_b32 v228, v2, v196, s30
v_mfma_f32_16x16x32_bf16 v[16:19], v[220:223], v[160:163], v[16:19]
v_perm_b32 v229, v2, v196, s31
s_waitcnt lgkmcnt(4)
v_fmac_f32 v24, v248, v246
v_mfma_f32_16x16x32_bf16 v[16:19], v[224:227], v[176:179], v[16:19]
v_perm_b32 v230, v2, v197, s30
v_fmac_f32 v25, v249, v246
v_mfma_f32_16x16x32_bf16 v[20:23], v[224:227], v[180:183], v[20:23]
v_perm_b32 v231, v2, v197, s31
v_fmac_f32 v28, v248, v247
v_fmac_f32 v29, v249, v247
v_mfma_f32_16x16x32_bf16 v[20:23], v[220:223], v[164:167], v[20:23]
v_perm_b32 v232, v2, v198, s30
v_fmac_f32 v30, v250, v247
v_mfma_f32_16x16x32_bf16 v[24:27], v[220:223], v[168:171], v[24:27]
ds_read_b128 v[204:207], v242 offset:30912
v_perm_b32 v233, v2, v198, s31
v_mfma_f32_16x16x32_bf16 v[24:27], v[224:227], v[184:187], v[24:27]
v_perm_b32 v234, v2, v199, s30
s_waitcnt lgkmcnt(4)
v_fmac_f32 v32, v208, v244
v_fmac_f32 v33, v209, v244
v_mfma_f32_16x16x32_bf16 v[28:31], v[224:227], v[188:191], v[28:31]
v_perm_b32 v235, v2, v199, s31
v_fmac_f32 v16, v248, v244
v_mfma_f32_16x16x32_bf16 v[28:31], v[220:223], v[172:175], v[28:31]
s_waitcnt lgkmcnt(1)
v_perm_b32 v220, v2, v200, s30
v_fmac_f32 v17, v249, v244
v_mfma_f32_16x16x32_bf16 v[32:35], v[228:231], v[160:163], v[32:35]
v_perm_b32 v221, v2, v200, s31
v_fmac_f32 v18, v250, v244
v_mfma_f32_16x16x32_bf16 v[32:35], v[232:235], v[176:179], v[32:35]
v_perm_b32 v222, v2, v201, s30
v_fmac_f32 v19, v251, v244
v_mfma_f32_16x16x32_bf16 v[36:39], v[232:235], v[180:183], v[36:39]
v_perm_b32 v223, v2, v201, s31
v_fmac_f32 v26, v250, v246
v_fmac_f32 v27, v251, v246
v_mfma_f32_16x16x32_bf16 v[36:39], v[228:231], v[164:167], v[36:39]
s_barrier
v_perm_b32 v224, v2, v202, s30
v_mfma_f32_16x16x32_bf16 v[40:43], v[228:231], v[168:171], v[40:43]
ds_read_b128 v[192:195], v12 offset:0
v_perm_b32 v225, v2, v202, s31
v_mfma_f32_16x16x32_bf16 v[40:43], v[232:235], v[184:187], v[40:43]
ds_read_b128 v[128:131], v10 offset:0
v_perm_b32 v226, v2, v203, s30
v_fmac_f32 v31, v251, v247
v_mfma_f32_16x16x32_bf16 v[44:47], v[232:235], v[188:191], v[44:47]
ds_read_b128 v[144:147], v11 offset:0
v_perm_b32 v227, v2, v203, s31
v_mfma_f32_16x16x32_bf16 v[44:47], v[228:231], v[172:175], v[44:47]
s_waitcnt lgkmcnt(3)
v_perm_b32 v228, v2, v204, s30
v_fmac_f32 v34, v210, v244
v_mfma_f32_16x16x32_bf16 v[48:51], v[220:223], v[160:163], v[48:51]
ds_read_b128 v[132:135], v10 offset:2048
v_perm_b32 v229, v2, v204, s31
v_mfma_f32_16x16x32_bf16 v[48:51], v[224:227], v[176:179], v[48:51]
ds_read_b128 v[148:151], v11 offset:2048
v_perm_b32 v230, v2, v205, s30
v_mfma_f32_16x16x32_bf16 v[52:55], v[224:227], v[180:183], v[52:55]
ds_read_b128 v[136:139], v10 offset:4096
v_perm_b32 v231, v2, v205, s31
v_fmac_f32 v35, v211, v244
v_mfma_f32_16x16x32_bf16 v[52:55], v[220:223], v[164:167], v[52:55]
ds_read_b128 v[152:155], v11 offset:4096
v_perm_b32 v232, v2, v206, s30
v_mfma_f32_16x16x32_bf16 v[56:59], v[220:223], v[168:171], v[56:59]
ds_read_b128 v[196:199], v12 offset:64
v_perm_b32 v233, v2, v206, s31
v_mfma_f32_16x16x32_bf16 v[56:59], v[224:227], v[184:187], v[56:59]
ds_read_b128 v[140:143], v10 offset:6144
v_perm_b32 v234, v2, v207, s30
v_fmac_f32 v20, v248, v245
v_mfma_f32_16x16x32_bf16 v[60:63], v[224:227], v[188:191], v[60:63]
ds_read_b128 v[156:159], v11 offset:6144
v_perm_b32 v235, v2, v207, s31
v_mfma_f32_16x16x32_bf16 v[60:63], v[220:223], v[172:175], v[60:63]
s_waitcnt lgkmcnt(9)
v_perm_b32 v220, v2, v192, s30
v_fmac_f32 v21, v249, v245
v_mfma_f32_16x16x32_bf16 v[64:67], v[228:231], v[160:163], v[64:67]
v_perm_b32 v221, v2, v192, s31
v_fmac_f32 v22, v250, v245
v_mfma_f32_16x16x32_bf16 v[64:67], v[232:235], v[176:179], v[64:67]
v_perm_b32 v222, v2, v193, s30
v_fmac_f32 v23, v251, v245
v_mfma_f32_16x16x32_bf16 v[68:71], v[232:235], v[180:183], v[68:71]
v_perm_b32 v223, v2, v193, s31
v_fmac_f32 v36, v208, v245
v_fmac_f32 v37, v209, v245
v_mfma_f32_16x16x32_bf16 v[68:71], v[228:231], v[164:167], v[68:71]
v_perm_b32 v224, v2, v194, s30
v_fmac_f32 v38, v210, v245
v_mfma_f32_16x16x32_bf16 v[72:75], v[228:231], v[168:171], v[72:75]
ds_read_b128 v[200:203], v12 offset:128
v_perm_b32 v225, v2, v194, s31
v_mfma_f32_16x16x32_bf16 v[72:75], v[232:235], v[184:187], v[72:75]
v_perm_b32 v226, v2, v195, s30
v_fmac_f32 v39, v211, v245
v_fmac_f32 v40, v208, v246
v_mfma_f32_16x16x32_bf16 v[76:79], v[232:235], v[188:191], v[76:79]
v_perm_b32 v227, v2, v195, s31
v_fmac_f32 v41, v209, v246
v_mfma_f32_16x16x32_bf16 v[76:79], v[228:231], v[172:175], v[76:79]
s_waitcnt lgkmcnt(3)
v_perm_b32 v228, v2, v196, s30
v_fmac_f32 v42, v210, v246
v_mfma_f32_16x16x32_bf16 v[16:19], v[220:223], v[128:131], v[16:19]
v_perm_b32 v229, v2, v196, s31
v_fmac_f32 v43, v211, v246
v_mfma_f32_16x16x32_bf16 v[16:19], v[224:227], v[144:147], v[16:19]
v_perm_b32 v230, v2, v197, s30
v_fmac_f32 v44, v208, v247
v_mfma_f32_16x16x32_bf16 v[20:23], v[224:227], v[148:151], v[20:23]
v_perm_b32 v231, v2, v197, s31
v_fmac_f32 v45, v209, v247
v_fmac_f32 v46, v210, v247
v_mfma_f32_16x16x32_bf16 v[20:23], v[220:223], v[132:135], v[20:23]
v_perm_b32 v232, v2, v198, s30
v_fmac_f32 v47, v211, v247
v_mfma_f32_16x16x32_bf16 v[24:27], v[220:223], v[136:139], v[24:27]
ds_read_b128 v[204:207], v12 offset:192
v_perm_b32 v233, v2, v198, s31
v_mfma_f32_16x16x32_bf16 v[24:27], v[224:227], v[152:155], v[24:27]
v_perm_b32 v234, v2, v199, s30
v_fmac_f32 v48, v212, v244
v_fmac_f32 v49, v213, v244
s_waitcnt lgkmcnt(2)
v_mfma_f32_16x16x32_bf16 v[28:31], v[224:227], v[156:159], v[28:31]
v_perm_b32 v235, v2, v199, s31
v_fmac_f32 v50, v214, v244
v_mfma_f32_16x16x32_bf16 v[28:31], v[220:223], v[140:143], v[28:31]
s_waitcnt lgkmcnt(1)
v_perm_b32 v220, v2, v200, s30
v_fmac_f32 v51, v215, v244
v_mfma_f32_16x16x32_bf16 v[32:35], v[228:231], v[128:131], v[32:35]
v_perm_b32 v221, v2, v200, s31
v_fmac_f32 v52, v212, v245
v_mfma_f32_16x16x32_bf16 v[32:35], v[232:235], v[144:147], v[32:35]
v_perm_b32 v222, v2, v201, s30
v_fmac_f32 v53, v213, v245
v_mfma_f32_16x16x32_bf16 v[36:39], v[232:235], v[148:151], v[36:39]
v_perm_b32 v223, v2, v201, s31
v_fmac_f32 v54, v214, v245
v_fmac_f32 v55, v215, v245
v_mfma_f32_16x16x32_bf16 v[36:39], v[228:231], v[132:135], v[36:39]
s_barrier
v_perm_b32 v224, v2, v202, s30
v_mfma_f32_16x16x32_bf16 v[40:43], v[228:231], v[136:139], v[40:43]
ds_read_b128 v[192:195], v12 offset:30720
v_perm_b32 v225, v2, v202, s31
v_mfma_f32_16x16x32_bf16 v[40:43], v[232:235], v[152:155], v[40:43]
ds_read_b128 v[160:163], v10 offset:30720
v_perm_b32 v226, v2, v203, s30
v_fmac_f32 v56, v212, v246
L_pad1:
s_cbranch_execz L_padret
v_mfma_f32_16x16x32_bf16 v[44:47], v[232:235], v[156:159], v[44:47]
ds_read_b128 v[176:179], v11 offset:30720
v_perm_b32 v227, v2, v203, s31
v_mfma_f32_16x16x32_bf16 v[44:47], v[228:231], v[140:143], v[44:47]
s_waitcnt lgkmcnt(3)
v_perm_b32 v228, v2, v204, s30
v_fmac_f32 v57, v213, v246
v_mfma_f32_16x16x32_bf16 v[48:51], v[220:223], v[128:131], v[48:51]
ds_read_b128 v[164:167], v10 offset:32768
v_perm_b32 v229, v2, v204, s31
v_mfma_f32_16x16x32_bf16 v[48:51], v[224:227], v[144:147], v[48:51]
ds_read_b128 v[180:183], v11 offset:32768
v_perm_b32 v230, v2, v205, s30
v_mfma_f32_16x16x32_bf16 v[52:55], v[224:227], v[148:151], v[52:55]
ds_read_b128 v[168:171], v10 offset:34816
v_perm_b32 v231, v2, v205, s31
v_fmac_f32 v60, v212, v247
v_mfma_f32_16x16x32_bf16 v[52:55], v[220:223], v[132:135], v[52:55]
ds_read_b128 v[184:187], v11 offset:34816
v_perm_b32 v232, v2, v206, s30
v_mfma_f32_16x16x32_bf16 v[56:59], v[220:223], v[136:139], v[56:59]
ds_read_b128 v[196:199], v12 offset:30784
v_perm_b32 v233, v2, v206, s31
v_mfma_f32_16x16x32_bf16 v[56:59], v[224:227], v[152:155], v[56:59]
ds_read_b128 v[172:175], v10 offset:36864
v_perm_b32 v234, v2, v207, s30
v_fmac_f32 v64, v216, v244
v_mfma_f32_16x16x32_bf16 v[60:63], v[224:227], v[156:159], v[60:63]
ds_read_b128 v[188:191], v11 offset:36864
v_perm_b32 v235, v2, v207, s31
v_mfma_f32_16x16x32_bf16 v[60:63], v[220:223], v[140:143], v[60:63]
s_waitcnt lgkmcnt(9)
v_perm_b32 v220, v2, v192, s30
v_fmac_f32 v68, v216, v245
v_mfma_f32_16x16x32_bf16 v[64:67], v[228:231], v[128:131], v[64:67]
v_perm_b32 v221, v2, v192, s31
v_fmac_f32 v72, v216, v246
v_mfma_f32_16x16x32_bf16 v[64:67], v[232:235], v[144:147], v[64:67]
v_perm_b32 v222, v2, v193, s30
v_fmac_f32 v73, v217, v246
v_mfma_f32_16x16x32_bf16 v[68:71], v[232:235], v[148:151], v[68:71]
v_perm_b32 v223, v2, v193, s31
v_fmac_f32 v58, v214, v246
v_fmac_f32 v59, v215, v246
v_mfma_f32_16x16x32_bf16 v[68:71], v[228:231], v[132:135], v[68:71]
v_perm_b32 v224, v2, v194, s30
v_fmac_f32 v76, v216, v247
v_mfma_f32_16x16x32_bf16 v[72:75], v[228:231], v[136:139], v[72:75]
ds_read_b128 v[200:203], v12 offset:30848
v_perm_b32 v225, v2, v194, s31
v_mfma_f32_16x16x32_bf16 v[72:75], v[232:235], v[152:155], v[72:75]
v_perm_b32 v226, v2, v195, s30
v_fmac_f32 v61, v213, v247
v_fmac_f32 v62, v214, v247
v_mfma_f32_16x16x32_bf16 v[76:79], v[232:235], v[156:159], v[76:79]
v_perm_b32 v227, v2, v195, s31
v_fmac_f32 v63, v215, v247
v_mfma_f32_16x16x32_bf16 v[76:79], v[228:231], v[140:143], v[76:79]
s_waitcnt lgkmcnt(3)
v_perm_b32 v228, v2, v196, s30
v_fmac_f32 v65, v217, v244
v_mfma_f32_16x16x32_bf16 v[16:19], v[220:223], v[160:163], v[16:19]
ds_read_b128 v[128:131], v240 offset:0
v_perm_b32 v229, v2, v196, s31
v_mfma_f32_16x16x32_bf16 v[16:19], v[224:227], v[176:179], v[16:19]
ds_read_b128 v[144:147], v241 offset:0
v_perm_b32 v230, v2, v197, s30
v_mfma_f32_16x16x32_bf16 v[20:23], v[224:227], v[180:183], v[20:23]
ds_read_b128 v[132:135], v240 offset:2048
v_perm_b32 v231, v2, v197, s31
v_fmac_f32 v66, v218, v244
v_mfma_f32_16x16x32_bf16 v[20:23], v[220:223], v[164:167], v[20:23]
ds_read_b128 v[148:151], v241 offset:2048
v_perm_b32 v232, v2, v198, s30
v_mfma_f32_16x16x32_bf16 v[24:27], v[220:223], v[168:171], v[24:27]
ds_read_b128 v[204:207], v12 offset:30912
v_perm_b32 v233, v2, v198, s31
v_mfma_f32_16x16x32_bf16 v[24:27], v[224:227], v[184:187], v[24:27]
ds_read_b128 v[136:139], v240 offset:4096
v_perm_b32 v234, v2, v199, s30
v_fmac_f32 v67, v219, v244
s_waitcnt lgkmcnt(7)
v_mfma_f32_16x16x32_bf16 v[28:31], v[224:227], v[188:191], v[28:31]
ds_read_b128 v[152:155], v241 offset:4096
v_perm_b32 v235, v2, v199, s31
v_mfma_f32_16x16x32_bf16 v[28:31], v[220:223], v[172:175], v[28:31]
ds_read_b128 v[236:239], v6 offset:0
s_waitcnt lgkmcnt(8)
v_perm_b32 v220, v2, v200, s30
v_fmac_f32 v77, v217, v247
v_mfma_f32_16x16x32_bf16 v[32:35], v[228:231], v[160:163], v[32:35]
ds_read_b128 v[140:143], v240 offset:6144
v_perm_b32 v221, v2, v200, s31
v_mfma_f32_16x16x32_bf16 v[32:35], v[232:235], v[176:179], v[32:35]
ds_read_b128 v[156:159], v241 offset:6144
v_perm_b32 v222, v2, v201, s30
v_mfma_f32_16x16x32_bf16 v[36:39], v[232:235], v[180:183], v[36:39]
ds_read_b128 v[248:251], v6 offset:64
v_perm_b32 v223, v2, v201, s31
v_fmac_f32 v78, v218, v247
v_fmac_f32 v79, v219, v247
v_mfma_f32_16x16x32_bf16 v[36:39], v[228:231], v[164:167], v[36:39]
ds_read_b128 v[208:211], v6 offset:128
v_perm_b32 v224, v2, v202, s30
v_fmac_f32 v74, v218, v246
v_mfma_f32_16x16x32_bf16 v[40:43], v[228:231], v[168:171], v[40:43]
ds_read_b128 v[192:195], v242 offset:256
v_perm_b32 v225, v2, v202, s31
v_mfma_f32_16x16x32_bf16 v[40:43], v[232:235], v[184:187], v[40:43]
ds_read_b128 v[212:215], v6 offset:192
v_perm_b32 v226, v2, v203, s30
v_fmac_f32 v75, v219, v246
v_fmac_f32 v69, v217, v245
v_mfma_f32_16x16x32_bf16 v[44:47], v[232:235], v[188:191], v[44:47]
v_perm_b32 v227, v2, v203, s31
v_fmac_f32 v70, v218, v245
v_mfma_f32_16x16x32_bf16 v[44:47], v[228:231], v[172:175], v[44:47]
s_waitcnt lgkmcnt(9)
v_perm_b32 v228, v2, v204, s30
v_fmac_f32 v71, v219, v245
v_mfma_f32_16x16x32_bf16 v[48:51], v[220:223], v[160:163], v[48:51]
v_perm_b32 v229, v2, v204, s31
s_waitcnt lgkmcnt(6)
v_mul_f32 v16, v236, v16
v_mfma_f32_16x16x32_bf16 v[48:51], v[224:227], v[176:179], v[48:51]
v_perm_b32 v230, v2, v205, s30
v_mul_f32 v17, v237, v17
v_mul_f32 v18, v238, v18
v_mfma_f32_16x16x32_bf16 v[52:55], v[224:227], v[180:183], v[52:55]
v_perm_b32 v231, v2, v205, s31
v_mul_f32 v19, v239, v19
v_mfma_f32_16x16x32_bf16 v[52:55], v[220:223], v[164:167], v[52:55]
v_perm_b32 v232, v2, v206, s30
v_cvt_pk_bf16_f32 v16, v16, v17
v_cvt_pk_bf16_f32 v17, v18, v19
v_mfma_f32_16x16x32_bf16 v[56:59], v[220:223], v[168:171], v[56:59]
ds_read_b128 v[196:199], v242 offset:320
v_perm_b32 v233, v2, v206, s31
s_waitcnt lgkmcnt(4)
v_mul_f32 v32, v248, v32
v_mfma_f32_16x16x32_bf16 v[56:59], v[224:227], v[184:187], v[56:59]
ds_write_b64 v5, v[16:17] offset:0
v_perm_b32 v234, v2, v207, s30
v_mfma_f32_16x16x32_bf16 v[60:63], v[224:227], v[188:191], v[60:63]
v_perm_b32 v235, v2, v207, s31
v_mul_f32 v33, v249, v33
v_mul_f32 v34, v250, v34
v_mfma_f32_16x16x32_bf16 v[60:63], v[220:223], v[172:175], v[60:63]
s_waitcnt lgkmcnt(3)
v_perm_b32 v220, v2, v192, s30
v_mul_f32 v35, v251, v35
v_mfma_f32_16x16x32_bf16 v[64:67], v[228:231], v[160:163], v[64:67]
v_perm_b32 v221, v2, v192, s31
v_cvt_pk_bf16_f32 v32, v32, v33
v_mfma_f32_16x16x32_bf16 v[64:67], v[232:235], v[176:179], v[64:67]
v_perm_b32 v222, v2, v193, s30
v_cvt_pk_bf16_f32 v33, v34, v35
v_mul_f32 v48, v208, v48
v_mfma_f32_16x16x32_bf16 v[68:71], v[232:235], v[180:183], v[68:71]
ds_write_b64 v5, v[32:33] offset:32
v_perm_b32 v223, v2, v193, s31
v_mul_f32 v49, v209, v49
v_mfma_f32_16x16x32_bf16 v[68:71], v[228:231], v[164:167], v[68:71]
v_perm_b32 v224, v2, v194, s30
v_mul_f32 v50, v210, v50
v_mfma_f32_16x16x32_bf16 v[72:75], v[228:231], v[168:171], v[72:75]
ds_read_b128 v[200:203], v242 offset:384
v_perm_b32 v225, v2, v194, s31
v_mul_f32 v51, v211, v51
v_mfma_f32_16x16x32_bf16 v[72:75], v[232:235], v[184:187], v[72:75]
v_perm_b32 v226, v2, v195, s30
v_cvt_pk_bf16_f32 v48, v48, v49
v_cvt_pk_bf16_f32 v49, v50, v51
v_mfma_f32_16x16x32_bf16 v[76:79], v[232:235], v[188:191], v[76:79]
ds_write_b64 v5, v[48:49] offset:64
v_perm_b32 v227, v2, v195, s31
v_mfma_f32_16x16x32_bf16 v[76:79], v[228:231], v[172:175], v[76:79]
s_waitcnt lgkmcnt(4)
v_perm_b32 v228, v2, v196, s30
v_mul_f32 v64, v212, v64
v_mfma_f32_16x16x32_bf16 v[80:83], v[220:223], v[128:131], v[80:83]
ds_read_b128 v[160:163], v240 offset:30720
v_perm_b32 v229, v2, v196, s31
v_mul_f32 v65, v213, v65
v_mfma_f32_16x16x32_bf16 v[80:83], v[224:227], v[144:147], v[80:83]
ds_read_b128 v[176:179], v241 offset:30720
v_perm_b32 v230, v2, v197, s30
v_mfma_f32_16x16x32_bf16 v[84:87], v[224:227], v[148:151], v[84:87]
ds_read_b128 v[164:167], v240 offset:32768
v_perm_b32 v231, v2, v197, s31
v_mul_f32 v66, v214, v66
v_mfma_f32_16x16x32_bf16 v[84:87], v[220:223], v[132:135], v[84:87]
ds_read_b128 v[180:183], v241 offset:32768
v_perm_b32 v232, v2, v198, s30
v_mul_f32 v67, v215, v67
v_mfma_f32_16x16x32_bf16 v[88:91], v[220:223], v[136:139], v[88:91]
ds_read_b128 v[204:207], v242 offset:30976
v_perm_b32 v233, v2, v198, s31
v_mfma_f32_16x16x32_bf16 v[88:91], v[224:227], v[152:155], v[88:91]
ds_read_b128 v[168:171], v240 offset:34816
v_perm_b32 v234, v2, v199, s30
v_cvt_pk_bf16_f32 v64, v64, v65
v_mfma_f32_16x16x32_bf16 v[92:95], v[224:227], v[156:159], v[92:95]
ds_read_b128 v[184:187], v241 offset:34816
v_perm_b32 v235, v2, v199, s31
v_cvt_pk_bf16_f32 v65, v66, v67
v_mfma_f32_16x16x32_bf16 v[92:95], v[220:223], v[140:143], v[92:95]
ds_write_b64 v5, v[64:65] offset:96
s_waitcnt lgkmcnt(9)
v_perm_b32 v220, v2, v200, s30
v_mfma_f32_16x16x32_bf16 v[96:99], v[228:231], v[128:131], v[96:99]
ds_read_b128 v[172:175], v240 offset:36864
v_perm_b32 v221, v2, v200, s31
v_mfma_f32_16x16x32_bf16 v[96:99], v[232:235], v[144:147], v[96:99]
ds_read_b128 v[188:191], v241 offset:36864
v_perm_b32 v222, v2, v201, s30
v_mul_f32 v20, v236, v20
v_mfma_f32_16x16x32_bf16 v[100:103], v[232:235], v[148:151], v[100:103]
v_perm_b32 v223, v2, v201, s31
v_mul_f32 v21, v237, v21
v_mfma_f32_16x16x32_bf16 v[100:103], v[228:231], v[132:135], v[100:103]
s_waitcnt lgkmcnt(2)
s_barrier
v_perm_b32 v224, v2, v202, s30
v_mfma_f32_16x16x32_bf16 v[104:107], v[228:231], v[136:139], v[104:107]
ds_read_b128 v[192:195], v242 offset:31040
v_perm_b32 v225, v2, v202, s31
v_mul_f32 v22, v238, v22
v_mfma_f32_16x16x32_bf16 v[104:107], v[232:235], v[152:155], v[104:107]
v_perm_b32 v226, v2, v203, s30
v_mul_f32 v23, v239, v23
v_mfma_f32_16x16x32_bf16 v[108:111], v[232:235], v[156:159], v[108:111]
v_perm_b32 v227, v2, v203, s31
v_cvt_pk_bf16_f32 v20, v20, v21
v_cvt_pk_bf16_f32 v21, v22, v23
v_mfma_f32_16x16x32_bf16 v[108:111], v[228:231], v[140:143], v[108:111]
ds_write_b64 v5, v[20:21] offset:4352
v_perm_b32 v228, v2, v204, s30
v_mfma_f32_16x16x32_bf16 v[112:115], v[220:223], v[128:131], v[112:115]
v_perm_b32 v229, v2, v204, s31
v_mul_f32 v36, v248, v36
v_mfma_f32_16x16x32_bf16 v[112:115], v[224:227], v[144:147], v[112:115]
v_perm_b32 v230, v2, v205, s30
v_mul_f32 v37, v249, v37
v_mul_f32 v38, v250, v38
v_mfma_f32_16x16x32_bf16 v[116:119], v[224:227], v[148:151], v[116:119]
v_perm_b32 v231, v2, v205, s31
v_mul_f32 v39, v251, v39
v_cvt_pk_bf16_f32 v36, v36, v37
v_mfma_f32_16x16x32_bf16 v[116:119], v[220:223], v[132:135], v[116:119]
v_perm_b32 v232, v2, v206, s30
v_cvt_pk_bf16_f32 v37, v38, v39
v_mfma_f32_16x16x32_bf16 v[120:123], v[220:223], v[136:139], v[120:123]
ds_read_b128 v[196:199], v242 offset:31104
v_perm_b32 v233, v2, v206, s31
v_mul_f32 v52, v208, v52
v_mfma_f32_16x16x32_bf16 v[120:123], v[224:227], v[152:155], v[120:123]
ds_write_b64 v5, v[36:37] offset:4384
v_perm_b32 v234, v2, v207, s30
v_mul_f32 v53, v209, v53
v_mfma_f32_16x16x32_bf16 v[124:127], v[224:227], v[156:159], v[124:127]
v_perm_b32 v235, v2, v207, s31
v_mul_f32 v54, v210, v54
v_mfma_f32_16x16x32_bf16 v[124:127], v[220:223], v[140:143], v[124:127]
s_waitcnt lgkmcnt(3)
v_perm_b32 v220, v2, v192, s30
v_mul_f32 v55, v211, v55
v_mfma_f32_16x16x32_bf16 v[80:83], v[228:231], v[160:163], v[80:83]
ds_read_b128 v[128:131], v10 offset:0
v_perm_b32 v221, v2, v192, s31
v_cvt_pk_bf16_f32 v52, v52, v53
v_mfma_f32_16x16x32_bf16 v[80:83], v[232:235], v[176:179], v[80:83]
ds_read_b128 v[144:147], v11 offset:0
v_perm_b32 v222, v2, v193, s30
v_mfma_f32_16x16x32_bf16 v[84:87], v[232:235], v[180:183], v[84:87]
ds_read_b128 v[132:135], v10 offset:2048
v_perm_b32 v223, v2, v193, s31
v_cvt_pk_bf16_f32 v53, v54, v55
v_mfma_f32_16x16x32_bf16 v[84:87], v[228:231], v[164:167], v[84:87]
ds_read_b128 v[148:151], v11 offset:2048
v_perm_b32 v224, v2, v194, s30
v_mul_f32 v68, v212, v68
v_mfma_f32_16x16x32_bf16 v[88:91], v[228:231], v[168:171], v[88:91]
ds_read_b128 v[200:203], v12 offset:256
v_perm_b32 v225, v2, v194, s31
v_mfma_f32_16x16x32_bf16 v[88:91], v[232:235], v[184:187], v[88:91]
ds_read_b128 v[136:139], v10 offset:4096
v_perm_b32 v226, v2, v195, s30
v_mul_f32 v69, v213, v69
v_mfma_f32_16x16x32_bf16 v[92:95], v[232:235], v[188:191], v[92:95]
ds_read_b128 v[152:155], v11 offset:4096
v_perm_b32 v227, v2, v195, s31
v_mul_f32 v70, v214, v70
v_mfma_f32_16x16x32_bf16 v[92:95], v[228:231], v[172:175], v[92:95]
ds_write_b64 v5, v[52:53] offset:4416
s_waitcnt lgkmcnt(9)
v_perm_b32 v228, v2, v196, s30
v_mfma_f32_16x16x32_bf16 v[96:99], v[220:223], v[160:163], v[96:99]
ds_read_b128 v[140:143], v10 offset:6144
v_perm_b32 v229, v2, v196, s31
v_mfma_f32_16x16x32_bf16 v[96:99], v[224:227], v[176:179], v[96:99]
ds_read_b128 v[156:159], v11 offset:6144
v_perm_b32 v230, v2, v197, s30
v_mul_f32 v71, v215, v71
v_mfma_f32_16x16x32_bf16 v[100:103], v[224:227], v[180:183], v[100:103]
v_perm_b32 v231, v2, v197, s31
v_cvt_pk_bf16_f32 v68, v68, v69
v_mfma_f32_16x16x32_bf16 v[100:103], v[220:223], v[164:167], v[100:103]
v_perm_b32 v232, v2, v198, s30
v_cvt_pk_bf16_f32 v69, v70, v71
v_mul_f32 v24, v236, v24
v_mfma_f32_16x16x32_bf16 v[104:107], v[220:223], v[168:171], v[104:107]
ds_read_b128 v[204:207], v12 offset:320
v_perm_b32 v233, v2, v198, s31
v_mul_f32 v25, v237, v25
v_mfma_f32_16x16x32_bf16 v[104:107], v[224:227], v[184:187], v[104:107]
ds_write_b64 v5, v[68:69] offset:4448
v_perm_b32 v234, v2, v199, s30
v_mfma_f32_16x16x32_bf16 v[108:111], v[224:227], v[188:191], v[108:111]
v_perm_b32 v235, v2, v199, s31
v_mul_f32 v26, v238, v26
v_mul_f32 v27, v239, v27
v_mfma_f32_16x16x32_bf16 v[108:111], v[220:223], v[172:175], v[108:111]
s_waitcnt lgkmcnt(7)
v_perm_b32 v220, v2, v200, s30
v_cvt_pk_bf16_f32 v24, v24, v25
v_mfma_f32_16x16x32_bf16 v[112:115], v[228:231], v[160:163], v[112:115]
v_perm_b32 v221, v2, v200, s31
v_cvt_pk_bf16_f32 v25, v26, v27
v_mfma_f32_16x16x32_bf16 v[112:115], v[232:235], v[176:179], v[112:115]
s_waitcnt lgkmcnt(0)
s_barrier
v_perm_b32 v222, v2, v201, s30
v_mfma_f32_16x16x32_bf16 v[116:119], v[232:235], v[180:183], v[116:119]
ds_write_b64 v5, v[24:25] offset:8704
v_perm_b32 v223, v2, v201, s31
v_mul_f32 v40, v248, v40
v_mfma_f32_16x16x32_bf16 v[116:119], v[228:231], v[164:167], v[116:119]
v_perm_b32 v224, v2, v202, s30
v_mul_f32 v41, v249, v41
v_mfma_f32_16x16x32_bf16 v[120:123], v[228:231], v[168:171], v[120:123]
ds_read_b128 v[192:195], v12 offset:384
v_perm_b32 v225, v2, v202, s31
v_mul_f32 v42, v250, v42
v_mfma_f32_16x16x32_bf16 v[120:123], v[232:235], v[184:187], v[120:123]
v_perm_b32 v226, v2, v203, s30
v_mul_f32 v43, v251, v43
v_cvt_pk_bf16_f32 v40, v40, v41
v_mfma_f32_16x16x32_bf16 v[124:127], v[232:235], v[188:191], v[124:127]
v_perm_b32 v227, v2, v203, s31
v_cvt_pk_bf16_f32 v41, v42, v43
v_mfma_f32_16x16x32_bf16 v[124:127], v[228:231], v[172:175], v[124:127]
ds_write_b64 v5, v[40:41] offset:8736
v_perm_b32 v228, v2, v204, s30
v_mfma_f32_16x16x32_bf16 v[80:83], v[220:223], v[128:131], v[80:83]
ds_read_b128 v[160:163], v10 offset:30720
v_perm_b32 v229, v2, v204, s31
v_mul_f32 v56, v208, v56
v_mfma_f32_16x16x32_bf16 v[80:83], v[224:227], v[144:147], v[80:83]
ds_read_b128 v[176:179], v11 offset:30720
v_perm_b32 v230, v2, v205, s30
v_mfma_f32_16x16x32_bf16 v[84:87], v[224:227], v[148:151], v[84:87]
ds_read_b128 v[164:167], v10 offset:32768
v_perm_b32 v231, v2, v205, s31
v_mul_f32 v57, v209, v57
v_mfma_f32_16x16x32_bf16 v[84:87], v[220:223], v[132:135], v[84:87]
ds_read_b128 v[180:183], v11 offset:32768
v_perm_b32 v232, v2, v206, s30
v_mul_f32 v58, v210, v58
v_mfma_f32_16x16x32_bf16 v[88:91], v[220:223], v[136:139], v[88:91]
ds_read_b128 v[196:199], v12 offset:30976
v_perm_b32 v233, v2, v206, s31
v_mfma_f32_16x16x32_bf16 v[88:91], v[224:227], v[152:155], v[88:91]
ds_read_b128 v[168:171], v10 offset:34816
v_perm_b32 v234, v2, v207, s30
v_mul_f32 v59, v211, v59
v_mfma_f32_16x16x32_bf16 v[92:95], v[224:227], v[156:159], v[92:95]
ds_read_b128 v[184:187], v11 offset:34816
v_perm_b32 v235, v2, v207, s31
v_cvt_pk_bf16_f32 v56, v56, v57
v_mfma_f32_16x16x32_bf16 v[92:95], v[220:223], v[140:143], v[92:95]
s_waitcnt lgkmcnt(8)
v_perm_b32 v220, v2, v192, s30
v_mfma_f32_16x16x32_bf16 v[96:99], v[228:231], v[128:131], v[96:99]
ds_read_b128 v[172:175], v10 offset:36864
v_perm_b32 v221, v2, v192, s31
v_cvt_pk_bf16_f32 v57, v58, v59
v_mfma_f32_16x16x32_bf16 v[96:99], v[232:235], v[144:147], v[96:99]
ds_read_b128 v[188:191], v11 offset:36864
v_perm_b32 v222, v2, v193, s30
v_mul_f32 v72, v212, v72
v_mfma_f32_16x16x32_bf16 v[100:103], v[232:235], v[148:151], v[100:103]
ds_write_b64 v5, v[56:57] offset:8768
v_perm_b32 v223, v2, v193, s31
v_mfma_f32_16x16x32_bf16 v[100:103], v[228:231], v[132:135], v[100:103]
v_perm_b32 v224, v2, v194, s30
v_mul_f32 v73, v213, v73
v_mul_f32 v74, v214, v74
v_mfma_f32_16x16x32_bf16 v[104:107], v[228:231], v[136:139], v[104:107]
ds_read_b128 v[200:203], v12 offset:31040
v_perm_b32 v225, v2, v194, s31
v_mul_f32 v75, v215, v75
v_mfma_f32_16x16x32_bf16 v[104:107], v[232:235], v[152:155], v[104:107]
v_perm_b32 v226, v2, v195, s30
v_cvt_pk_bf16_f32 v72, v72, v73
v_mfma_f32_16x16x32_bf16 v[108:111], v[232:235], v[156:159], v[108:111]
v_perm_b32 v227, v2, v195, s31
v_cvt_pk_bf16_f32 v73, v74, v75
v_mul_f32 v28, v236, v28
v_mfma_f32_16x16x32_bf16 v[108:111], v[228:231], v[140:143], v[108:111]
ds_write_b64 v5, v[72:73] offset:8800
s_waitcnt lgkmcnt(7)
v_perm_b32 v228, v2, v196, s30
v_mfma_f32_16x16x32_bf16 v[112:115], v[220:223], v[128:131], v[112:115]
v_perm_b32 v229, v2, v196, s31
v_mul_f32 v29, v237, v29
v_mfma_f32_16x16x32_bf16 v[112:115], v[224:227], v[144:147], v[112:115]
v_perm_b32 v230, v2, v197, s30
v_mul_f32 v30, v238, v30
v_mul_f32 v31, v239, v31
v_mfma_f32_16x16x32_bf16 v[116:119], v[224:227], v[148:151], v[116:119]
v_perm_b32 v231, v2, v197, s31
v_cvt_pk_bf16_f32 v28, v28, v29
v_cvt_pk_bf16_f32 v29, v30, v31
v_mfma_f32_16x16x32_bf16 v[116:119], v[220:223], v[132:135], v[116:119]
s_waitcnt lgkmcnt(0)
s_barrier
v_perm_b32 v232, v2, v198, s30
v_mfma_f32_16x16x32_bf16 v[120:123], v[220:223], v[136:139], v[120:123]
ds_read_b128 v[204:207], v12 offset:31104
v_perm_b32 v233, v2, v198, s31
v_mfma_f32_16x16x32_bf16 v[120:123], v[224:227], v[152:155], v[120:123]
ds_write_b64 v5, v[28:29] offset:13056
v_perm_b32 v234, v2, v199, s30
v_mul_f32 v44, v248, v44
v_mfma_f32_16x16x32_bf16 v[124:127], v[224:227], v[156:159], v[124:127]
v_perm_b32 v235, v2, v199, s31
v_mul_f32 v45, v249, v45
v_mfma_f32_16x16x32_bf16 v[124:127], v[220:223], v[140:143], v[124:127]
v_perm_b32 v220, v2, v200, s30
v_mul_f32 v46, v250, v46
v_mfma_f32_16x16x32_bf16 v[80:83], v[228:231], v[160:163], v[80:83]
ds_read_b128 v[128:131], v6 offset:1152
v_perm_b32 v221, v2, v200, s31
v_mul_f32 v47, v251, v47
v_mfma_f32_16x16x32_bf16 v[80:83], v[232:235], v[176:179], v[80:83]
ds_read_b128 v[132:135], v6 offset:1216
v_perm_b32 v222, v2, v201, s30
v_mfma_f32_16x16x32_bf16 v[84:87], v[232:235], v[180:183], v[84:87]
ds_read_b128 v[136:139], v6 offset:1280
v_perm_b32 v223, v2, v201, s31
v_cvt_pk_bf16_f32 v44, v44, v45
v_mfma_f32_16x16x32_bf16 v[84:87], v[228:231], v[164:167], v[84:87]
ds_read_b128 v[140:143], v6 offset:256
v_perm_b32 v224, v2, v202, s30
v_cvt_pk_bf16_f32 v45, v46, v47
v_mfma_f32_16x16x32_bf16 v[88:91], v[228:231], v[168:171], v[88:91]
ds_read_b128 v[144:147], v6 offset:320
v_perm_b32 v225, v2, v202, s31
v_mfma_f32_16x16x32_bf16 v[88:91], v[232:235], v[184:187], v[88:91]
ds_read_b128 v[148:151], v6 offset:384
v_perm_b32 v226, v2, v203, s30
v_mul_f32 v60, v208, v60
v_mfma_f32_16x16x32_bf16 v[92:95], v[232:235], v[188:191], v[92:95]
ds_write_b64 v5, v[44:45] offset:13088
v_perm_b32 v227, v2, v203, s31
v_mul_f32 v61, v209, v61
v_mfma_f32_16x16x32_bf16 v[92:95], v[228:231], v[172:175], v[92:95]
s_waitcnt lgkmcnt(8)
v_perm_b32 v228, v2, v204, s30
v_mfma_f32_16x16x32_bf16 v[96:99], v[220:223], v[160:163], v[96:99]
v_perm_b32 v229, v2, v204, s31
v_mul_f32 v62, v210, v62
v_mul_f32 v63, v211, v63
v_mfma_f32_16x16x32_bf16 v[96:99], v[224:227], v[176:179], v[96:99]
v_perm_b32 v230, v2, v205, s30
v_cvt_pk_bf16_f32 v60, v60, v61
v_cvt_pk_bf16_f32 v61, v62, v63
v_mfma_f32_16x16x32_bf16 v[100:103], v[224:227], v[180:183], v[100:103]
ds_write_b64 v5, v[60:61] offset:13120
v_perm_b32 v231, v2, v205, s31
v_mfma_f32_16x16x32_bf16 v[100:103], v[220:223], v[164:167], v[100:103]
v_perm_b32 v232, v2, v206, s30
v_mul_f32 v76, v212, v76
v_mul_f32 v77, v213, v77
v_mfma_f32_16x16x32_bf16 v[104:107], v[220:223], v[168:171], v[104:107]
v_perm_b32 v233, v2, v206, s31
v_mul_f32 v78, v214, v78
v_mul_f32 v79, v215, v79
v_mfma_f32_16x16x32_bf16 v[104:107], v[224:227], v[184:187], v[104:107]
v_perm_b32 v234, v2, v207, s30
v_cvt_pk_bf16_f32 v76, v76, v77
v_mfma_f32_16x16x32_bf16 v[108:111], v[224:227], v[188:191], v[108:111]
v_perm_b32 v235, v2, v207, s31
v_cvt_pk_bf16_f32 v77, v78, v79
v_mfma_f32_16x16x32_bf16 v[108:111], v[220:223], v[172:175], v[108:111]
ds_write_b64 v5, v[76:77] offset:13152
v_mfma_f32_16x16x32_bf16 v[112:115], v[228:231], v[160:163], v[112:115]
v_mfma_f32_16x16x32_bf16 v[112:115], v[232:235], v[176:179], v[112:115]
v_mfma_f32_16x16x32_bf16 v[116:119], v[232:235], v[180:183], v[116:119]
v_mfma_f32_16x16x32_bf16 v[116:119], v[228:231], v[164:167], v[116:119]
s_waitcnt lgkmcnt(0)
s_barrier
v_mfma_f32_16x16x32_bf16 v[120:123], v[228:231], v[168:171], v[120:123]
v_mfma_f32_16x16x32_bf16 v[120:123], v[232:235], v[184:187], v[120:123]
v_mfma_f32_16x16x32_bf16 v[124:127], v[232:235], v[188:191], v[124:127]
v_mfma_f32_16x16x32_bf16 v[124:127], v[228:231], v[172:175], v[124:127]
s_waitcnt lgkmcnt(0)
v_pk_fma_f32 v[80:81], v[128:129], v[244:245], v[80:81] op_sel:[0,0,0] op_sel_hi:[1,0,1]
v_pk_fma_f32 v[82:83], v[130:131], v[244:245], v[82:83] op_sel:[0,0,0] op_sel_hi:[1,0,1]
v_pk_mul_f32 v[80:81], v[80:81], v[140:141]
v_pk_mul_f32 v[82:83], v[82:83], v[142:143]
v_cvt_pk_bf16_f32 v80, v80, v81
v_cvt_pk_bf16_f32 v81, v82, v83
ds_write_b64 v13, v[80:81] offset:0
v_pk_fma_f32 v[96:97], v[132:133], v[244:245], v[96:97] op_sel:[0,0,0] op_sel_hi:[1,0,1]
v_pk_fma_f32 v[98:99], v[134:135], v[244:245], v[98:99] op_sel:[0,0,0] op_sel_hi:[1,0,1]
v_pk_mul_f32 v[96:97], v[96:97], v[144:145]
v_pk_mul_f32 v[98:99], v[98:99], v[146:147]
v_cvt_pk_bf16_f32 v96, v96, v97
v_cvt_pk_bf16_f32 v97, v98, v99
ds_write_b64 v13, v[96:97] offset:32
s_nop 1
v_pk_fma_f32 v[112:113], v[136:137], v[244:245], v[112:113] op_sel:[0,0,0] op_sel_hi:[1,0,1]
v_pk_fma_f32 v[114:115], v[138:139], v[244:245], v[114:115] op_sel:[0,0,0] op_sel_hi:[1,0,1]
v_pk_mul_f32 v[112:113], v[112:113], v[148:149]
v_pk_mul_f32 v[114:115], v[114:115], v[150:151]
v_cvt_pk_bf16_f32 v112, v112, v113
v_cvt_pk_bf16_f32 v113, v114, v115
ds_write_b64 v13, v[112:113] offset:64
v_pk_fma_f32 v[84:85], v[128:129], v[244:245], v[84:85] op_sel:[0,1,0] op_sel_hi:[1,1,1]
v_pk_fma_f32 v[86:87], v[130:131], v[244:245], v[86:87] op_sel:[0,1,0] op_sel_hi:[1,1,1]
v_pk_mul_f32 v[84:85], v[84:85], v[140:141]
v_pk_mul_f32 v[86:87], v[86:87], v[142:143]
v_cvt_pk_bf16_f32 v84, v84, v85
v_cvt_pk_bf16_f32 v85, v86, v87
ds_write_b64 v13, v[84:85] offset:3328
v_pk_fma_f32 v[100:101], v[132:133], v[244:245], v[100:101] op_sel:[0,1,0] op_sel_hi:[1,1,1]
v_pk_fma_f32 v[102:103], v[134:135], v[244:245], v[102:103] op_sel:[0,1,0] op_sel_hi:[1,1,1]
v_pk_mul_f32 v[100:101], v[100:101], v[144:145]
v_pk_mul_f32 v[102:103], v[102:103], v[146:147]
v_cvt_pk_bf16_f32 v100, v100, v101
v_cvt_pk_bf16_f32 v101, v102, v103
ds_write_b64 v13, v[100:101] offset:3360
v_pk_fma_f32 v[116:117], v[136:137], v[244:245], v[116:117] op_sel:[0,1,0] op_sel_hi:[1,1,1]
v_pk_fma_f32 v[118:119], v[138:139], v[244:245], v[118:119] op_sel:[0,1,0] op_sel_hi:[1,1,1]
v_pk_mul_f32 v[116:117], v[116:117], v[148:149]
v_pk_mul_f32 v[118:119], v[118:119], v[150:151]
v_cvt_pk_bf16_f32 v116, v116, v117
v_cvt_pk_bf16_f32 v117, v118, v119
ds_write_b64 v13, v[116:117] offset:3392
s_waitcnt lgkmcnt(0)
s_barrier
v_pk_fma_f32 v[88:89], v[128:129], v[246:247], v[88:89] op_sel:[0,0,0] op_sel_hi:[1,0,1]
v_pk_fma_f32 v[90:91], v[130:131], v[246:247], v[90:91] op_sel:[0,0,0] op_sel_hi:[1,0,1]
v_pk_mul_f32 v[88:89], v[88:89], v[140:141]
v_pk_mul_f32 v[90:91], v[90:91], v[142:143]
v_cvt_pk_bf16_f32 v88, v88, v89
v_cvt_pk_bf16_f32 v89, v90, v91
ds_write_b64 v13, v[88:89] offset:6656
v_pk_fma_f32 v[104:105], v[132:133], v[246:247], v[104:105] op_sel:[0,0,0] op_sel_hi:[1,0,1]
v_pk_fma_f32 v[106:107], v[134:135], v[246:247], v[106:107] op_sel:[0,0,0] op_sel_hi:[1,0,1]
v_pk_mul_f32 v[104:105], v[104:105], v[144:145]
v_pk_mul_f32 v[106:107], v[106:107], v[146:147]
v_cvt_pk_bf16_f32 v104, v104, v105
v_cvt_pk_bf16_f32 v105, v106, v107
ds_write_b64 v13, v[104:105] offset:6688
v_pk_fma_f32 v[120:121], v[136:137], v[246:247], v[120:121] op_sel:[0,0,0] op_sel_hi:[1,0,1]
L_pad2:
s_cbranch_execz L_padret
v_pk_fma_f32 v[122:123], v[138:139], v[246:247], v[122:123] op_sel:[0,0,0] op_sel_hi:[1,0,1]
v_pk_mul_f32 v[120:121], v[120:121], v[148:149]
v_pk_mul_f32 v[122:123], v[122:123], v[150:151]
v_cvt_pk_bf16_f32 v120, v120, v121
v_cvt_pk_bf16_f32 v121, v122, v123
ds_write_b64 v13, v[120:121] offset:6720
v_pk_fma_f32 v[92:93], v[128:129], v[246:247], v[92:93] op_sel:[0,1,0] op_sel_hi:[1,1,1]
v_pk_fma_f32 v[94:95], v[130:131], v[246:247], v[94:95] op_sel:[0,1,0] op_sel_hi:[1,1,1]
v_pk_mul_f32 v[92:93], v[92:93], v[140:141]
v_pk_mul_f32 v[94:95], v[94:95], v[142:143]
v_cvt_pk_bf16_f32 v92, v92, v93
v_cvt_pk_bf16_f32 v93, v94, v95
ds_write_b64 v13, v[92:93] offset:9984
v_pk_fma_f32 v[108:109], v[132:133], v[246:247], v[108:109] op_sel:[0,1,0] op_sel_hi:[1,1,1]
v_pk_fma_f32 v[110:111], v[134:135], v[246:247], v[110:111] op_sel:[0,1,0] op_sel_hi:[1,1,1]
v_pk_mul_f32 v[108:109], v[108:109], v[144:145]
v_pk_mul_f32 v[110:111], v[110:111], v[146:147]
v_cvt_pk_bf16_f32 v108, v108, v109
v_cvt_pk_bf16_f32 v109, v110, v111
ds_write_b64 v13, v[108:109] offset:10016
v_pk_fma_f32 v[124:125], v[136:137], v[246:247], v[124:125] op_sel:[0,1,0] op_sel_hi:[1,1,1]
v_pk_fma_f32 v[126:127], v[138:139], v[246:247], v[126:127] op_sel:[0,1,0] op_sel_hi:[1,1,1]
v_pk_mul_f32 v[124:125], v[124:125], v[148:149]
v_pk_mul_f32 v[126:127], v[126:127], v[150:151]
v_cvt_pk_bf16_f32 v124, v124, v125
v_cvt_pk_bf16_f32 v125, v126, v127
ds_write_b64 v13, v[124:125] offset:10048
s_waitcnt lgkmcnt(0)
s_barrier
L_end:
s_endpgm
.p2align 6
L_load:
v_and_b32 v8, 15, v1
v_lshrrev_b32 v9, 4, v1
s_bfe_u32 s28, s14, 0x10001
s_lshl_b32 s28, s28, 6
s_and_b32 s29, s14, 1
s_lshl_b32 s29, s29, 3
s_add_u32 s28, s28, s29
v_cmp_le_u32 vcc, 12, v8
v_lshlrev_b32 v8, 4, v8
v_mul_u32_u24 v70, 7168, v9
v_add_u32 v70, v70, v8
v_add_u32 v9, s28, v9
v_bfrev_b32 v72, 1
v_cndmask_b32 v71, v70, v72, vcc
v_mul_u32_u24 v69, 272, v9
v_add_u32 v69, v69, v8
v_add_u32 v69, 125184, v69
v_mul_u32_u24 v68, 208, v9
v_add_u32 v68, v68, v8
s_lshl_b32 s29, s12, 7
s_add_u32 s28, s28, s29
s_mul_i32 s28, s28, 7168
s_mul_i32 s29, s13, 448
s_add_u32 s82, s28, s29
s_cmp_lt_u32 s14, 6
s_cbranch_scc1 L_wload
s_sub_u32 s50, s14, 6
v_lshrrev_b32 v8, 3, v1
s_lshl_b32 s28, s12, 7
s_lshl_b32 s29, s50, 6
s_add_u32 s28, s28, s29
v_add_u32 v8, s28, v8
v_lshlrev_b32 v8, 11, v8
v_and_b32 v9, 7, v1
v_lshrrev_b32 v6, 4, v1
v_xor_b32 v9, v9, v6
v_lshl_add_u32 v10, v9, 4, v8
v_xor_b32 v11, 64, v10
v_add_u32 v11, 15360, v11
v_add_u32 v12, 30720, v10
v_add_u32 v13, 30720, v11
s_lshl_b32 s20, s50, 13
s_mov_b32 s30, 0
s_mov_b32 s31, 65536
s_mov_b32 s32, 0
v_lshlrev_b32 v6, 4, v1
s_lshl_b32 s28, s12, 7
s_lshl_b32 s29, s13, 3
s_add_u32 s28, s28, s29
s_lshl_b32 s29, s50, 2
s_add_u32 s51, s28, s29
v_and_b32 v14, 15, v1
v_lshlrev_b32 v14, 4, v14
v_lshrrev_b32 v15, 4, v1
v_lshl_add_u32 v14, v15, 11, v14
s_waitcnt lgkmcnt(0)
s_mov_b32 s52, s4
s_and_b32 s53, s5, 0xffff
s_mov_b32 s54, 4194304
s_mov_b32 s55, 0x00020000
s_branch L_xiss_end
L_xiss:
s_add_u32 m0, s20, s32
s_add_u32 s32, s32, 30720
buffer_load_dwordx4 v10, s[52:55], s30 offen offset:0 lds
buffer_load_dwordx4 v11, s[52:55], s30 offen offset:1024 lds
buffer_load_dwordx4 v12, s[52:55], s30 offen offset:2048 lds
buffer_load_dwordx4 v13, s[52:55], s30 offen offset:3072 lds
s_add_u32 m0, m0, 4096
s_cmp_eq_u32 s32, 122880
buffer_load_dwordx4 v10, s[52:55], s31 offen offset:0 lds
buffer_load_dwordx4 v11, s[52:55], s31 offen offset:1024 lds
buffer_load_dwordx4 v12, s[52:55], s31 offen offset:2048 lds
buffer_load_dwordx4 v13, s[52:55], s31 offen offset:3072 lds
s_cselect_b32 s32, 0, s32
s_add_u32 s30, s30, 128
s_add_u32 s31, s31, 128
s_setpc_b64 s[72:73]
L_xiss_end:
s_mov_b32 s40, 0
s_lshl_b32 s28, s13, 7
s_add_u32 s28, s28, 5275648
s_load_dword s36, s[8:9], s28
s_lshl_b32 s29, s12, 7
s_add_u32 s29, s29, 5277696
s_load_dword s37, s[8:9], s29
s_load_dwordx4 s[44:47], s[0:1], 16
s_load_dwordx2 s[48:49], s[0:1], 32
s_mov_b32 s24, s8
s_and_b32 s25, s9, 0xffff
s_mov_b32 s26, 9961472
s_mov_b32 s27, 0x00020000
s_lshl_b32 s15, s50, 1
s_lshr_b32 s16, s12, 3
s_add_u32 s15, s15, s16
s_add_u32 s15, s15, 8
s_bfe_u32 s16, s12, 0x20001
s_and_b32 s17, s12, 1
s_lshl_b32 s18, s15, 3
s_add_u32 s18, s18, s16
s_mul_i32 s18, s18, 114688
s_mul_i32 s28, s13, 896
s_lshl_b32 s19, s17, 8
s_add_u32 s28, s28, s19
s_add_u32 s66, s18, s28
s_lshl_b32 s19, s17, 2
s_sub_u32 s19, 16, s19
v_lshrrev_b32 v3, 5, v1
v_and_b32 v5, 31, v1
v_mul_u32_u24 v4, 458752, v3
v_lshl_add_u32 v4, v5, 4, v4
v_and_b32 v9, 16, v1
v_mad_u32_u24 v4, v9, s19, v4
s_mov_b32 s34, 0x0fffffff
s_mov_b32 s35, 0x0fffffff
s_mov_b32 s70, 14680064
s_mov_b32 s71, 0x00020000
v_mul_u32_u24 v7, 448, v3
v_lshl_add_u32 v7, v5, 4, v7
s_lshl_b32 s28, s13, 4
s_add_u32 s28, s28, s15
s_mul_i32 s28, s28, 14336
s_mul_i32 s29, s17, 7168
s_add_u32 s28, s28, s29
s_mul_i32 s29, s16, 1792
s_add_u32 s28, s28, s29
s_add_u32 s67, s28, 1048576
s_mov_b32 s39, 0x0c0c0400
v_mov_b32 v15, 0x0f0f0f0f
s_mov_b32 s68, s6
s_mov_b32 s69, s7
s_waitcnt lgkmcnt(0)
s_bfe_u32 s36, s36, 0x10007
s_xor_b32 s36, s36, 1
s_mul_i32 s38, s36, 0x80808080
s_mul_i32 s37, s37, 0x41c64e6d
s_add_u32 s37, s37, 0x3039
s_mov_b32 s56, s46
s_and_b32 s57, s47, 0xffff
s_mov_b32 s58, 7168
s_mov_b32 s59, 0x00020000
s_mov_b32 s60, s44
s_and_b32 s61, s45, 0xffff
s_mov_b32 s62, 7168
s_mov_b32 s63, 0x00020000
s_mul_i32 s28, s13, 448
s_lshl_b32 s29, s50, 7
s_add_u32 s28, s28, s29
s_sub_u32 s29, 4, s50
v_lshlrev_b32 v8, 2, v1
v_and_b32 v9, 32, v1
v_mad_u32_u24 v8, v9, s29, v8
buffer_load_dword v48, v8, s[56:59], s28 offen
buffer_load_dword v49, v8, s[60:63], s28 offen
v_and_b32 v8, 15, v1
v_lshrrev_b32 v9, 4, v1
v_cmp_eq_u32 vcc, v8, v9
v_mov_b32 v9, 0x3f803f80
v_mov_b32 v61, 1.0
v_cndmask_b32 v64, 0, v9, vcc
v_mov_b32 v65, v64
v_mov_b32 v66, v64
v_mov_b32 v67, v64
s_lshl_b32 s74, s51, 4
s_add_u32 s74, s74, 5242880
s_waitcnt vmcnt(2)
s_call_b64 s[72:73], L_xiss
s_setprio 3
v_mfma_f32_16x16x32_bf16 v[52:55], v[16:19], v[64:67], 0
v_mfma_f32_16x16x32_bf16 v[52:55], v[20:23], v[64:67], v[52:55]
v_mfma_f32_16x16x32_bf16 v[52:55], v[24:27], v[64:67], v[52:55]
v_mfma_f32_16x16x32_bf16 v[52:55], v[28:31], v[64:67], v[52:55]
s_setprio 0
s_barrier
s_waitcnt vmcnt(8)
v_lshlrev_b32 v56, 16, v49
v_and_b32 v57, 0xffff0000, v49
v_lshlrev_b32 v58, 16, v48
v_and_b32 v59, 0xffff0000, v48
v_sub_f32 v58, 0xc3000000, v58
v_sub_f32 v59, 0xc3000000, v59
s_lshl_b32 s28, s36, 23
s_sub_u32 s29, 0x3f800000, s28
s_add_u32 s28, s28, 0x3f800000
v_mul_f32 v58, s29, v58
v_mul_f32 v59, s29, v59
v_mul_f32 v56, s28, v56
v_mul_f32 v57, s28, v57
s_mul_i32 s28, s50, 448
s_add_u32 s28, s28, 123392
v_lshlrev_b32 v8, 3, v1
v_add_u32 v8, s28, v8
s_mov_b32 exec_hi, 0x00ffffff
ds_write_b64 v8, v[56:57]
ds_write_b64 v8, v[58:59] offset:896
s_mov_b32 exec_hi, -1
s_waitcnt lgkmcnt(0)
s_call_b64 s[72:73], L_xiss
s_cmp_lg_u32 s50, 0
s_cbranch_scc1 L_xs1
s_waitcnt vmcnt(8)
s_barrier
s_call_b64 s[72:73], L_xiss
s_call_b64 s[72:73], L_uld
s_add_u32 s66, s66, 3569664
s_waitcnt vmcnt(16)
s_barrier
s_call_b64 s[72:73], L_xiss
s_waitcnt vmcnt(16)
s_barrier
s_waitcnt vmcnt(8)
s_call_b64 s[72:73], L_pk0
s_call_b64 s[72:73], L_xiss
s_lshl_b32 s28, s51, 11
buffer_load_dwordx4 v[32:35], v14, s[52:55], s28 offen offset:1024
buffer_load_dwordx4 v[36:39], v14, s[52:55], s28 offen offset:1280
s_waitcnt vmcnt(10)
s_barrier
s_call_b64 s[72:73], L_pk1
s_add_u32 s67, s67, 57344
s_call_b64 s[72:73], L_xiss
s_waitcnt vmcnt(12)
s_barrier
s_call_b64 s[72:73], L_xiss
s_call_b64 s[72:73], L_uld
s_add_u32 s66, s66, 3569664
s_lshl_b32 s28, s51, 11
buffer_load_dwordx4 v[40:43], v14, s[52:55], s28 offen offset:1536
buffer_load_dwordx4 v[44:47], v14, s[52:55], s28 offen offset:1792
s_waitcnt vmcnt(18)
s_barrier
s_call_b64 s[72:73], L_xiss
s_waitcnt vmcnt(18)
s_barrier
s_waitcnt vmcnt(10)
s_call_b64 s[72:73], L_pk0
s_waitcnt vmcnt(8)
s_setprio 3
v_mfma_f32_16x16x32_bf16 v[52:55], v[32:35], v[64:67], v[52:55]
v_mfma_f32_16x16x32_bf16 v[52:55], v[36:39], v[64:67], v[52:55]
v_mfma_f32_16x16x32_bf16 v[52:55], v[40:43], v[64:67], v[52:55]
v_mfma_f32_16x16x32_bf16 v[52:55], v[44:47], v[64:67], v[52:55]
s_setprio 0
s_call_b64 s[72:73], L_xiss
s_waitcnt vmcnt(8)
s_barrier
s_call_b64 s[72:73], L_pk1
s_add_u32 s67, s67, 57344
s_call_b64 s[72:73], L_xiss
s_waitcnt vmcnt(10)
s_barrier
s_nop 7
v_add_f32 v52, v52, v53
v_add_f32 v54, v54, v55
v_add_f32 v16, v52, v54
v_mov_b32 v53, v16
s_nop 1
v_permlane32_swap_b32 v16, v53
v_add_f32 v16, v16, v53
v_mov_b32 v53, v16
s_nop 1
v_permlane16_swap_b32 v16, v53
v_add_f32 v16, v16, v53
v_mov_b32 v17, s37
s_mov_b64 exec, 0xf
buffer_store_dwordx4 v[16:19], v6, s[24:27], s74 offen sc1
s_mov_b64 exec, -1
s_call_b64 s[72:73], L_xiss
s_waitcnt vmcnt(9)
s_barrier
s_call_b64 s[72:73], L_xiss
s_mov_b32 s84, s48
s_and_b32 s85, s49, 0xffff
s_mov_b32 s86, 14680064
s_mov_b32 s87, 0x00020000
s_lshl_b32 s28, s12, 7
s_mul_i32 s29, s50, 127
s_add_u32 s28, s28, s29
s_mul_i32 s28, s28, 7168
s_mul_i32 s29, s13, 448
s_add_u32 s28, s28, s29
s_mov_b64 exec, 0xf
buffer_store_dwordx4 v[64:67], v6, s[84:87], s28 offen sc1 nt
s_mov_b64 exec, -1
s_waitcnt vmcnt(9)
s_barrier
s_call_b64 s[72:73], L_xiss
s_lshl_b32 s75, s12, 11
s_lshl_b32 s29, s50, 10
s_add_u32 s75, s75, s29
s_add_u32 s75, s75, 5242880
buffer_load_dwordx2 v[62:63], v6, s[24:27], s75 offen sc1
s_waitcnt vmcnt(10)
s_barrier
s_waitcnt vmcnt(0)
s_call_b64 s[72:73], L_rchk
s_call_b64 s[72:73], L_xiss
s_barrier
s_call_b64 s[72:73], L_xiss
s_waitcnt vmcnt(8)
s_barrier
s_call_b64 s[72:73], L_xiss
s_waitcnt vmcnt(8)
s_barrier
s_waitcnt vmcnt(0)
s_branch L_xs_end
L_xs1:
s_waitcnt vmcnt(8)
s_barrier
s_call_b64 s[72:73], L_xiss
s_waitcnt vmcnt(8)
s_barrier
s_call_b64 s[72:73], L_xiss
s_waitcnt vmcnt(8)
s_barrier
s_call_b64 s[72:73], L_xiss
s_call_b64 s[72:73], L_uld
s_add_u32 s66, s66, 3569664
s_lshl_b32 s28, s51, 11
buffer_load_dwordx4 v[32:35], v14, s[52:55], s28 offen offset:1024
buffer_load_dwordx4 v[36:39], v14, s[52:55], s28 offen offset:1280
s_waitcnt vmcnt(18)
s_barrier
s_call_b64 s[72:73], L_xiss
s_waitcnt vmcnt(18)
s_barrier
s_waitcnt vmcnt(10)
s_call_b64 s[72:73], L_pk0
s_call_b64 s[72:73], L_xiss
s_lshl_b32 s28, s51, 11
buffer_load_dwordx4 v[40:43], v14, s[52:55], s28 offen offset:1536
buffer_load_dwordx4 v[44:47], v14, s[52:55], s28 offen offset:1792
s_waitcnt vmcnt(10)
s_barrier
s_call_b64 s[72:73], L_pk1
s_add_u32 s67, s67, 57344
s_call_b64 s[72:73], L_xiss
s_waitcnt vmcnt(12)
s_barrier
s_waitcnt vmcnt(10)
s_setprio 3
v_mfma_f32_16x16x32_bf16 v[52:55], v[32:35], v[64:67], v[52:55]
v_mfma_f32_16x16x32_bf16 v[52:55], v[36:39], v[64:67], v[52:55]
v_mfma_f32_16x16x32_bf16 v[52:55], v[40:43], v[64:67], v[52:55]
v_mfma_f32_16x16x32_bf16 v[52:55], v[44:47], v[64:67], v[52:55]
s_setprio 0
s_call_b64 s[72:73], L_xiss
s_call_b64 s[72:73], L_uld
s_add_u32 s66, s66, 3569664
s_waitcnt vmcnt(16)
s_barrier
s_nop 7
v_add_f32 v52, v52, v53
v_add_f32 v54, v54, v55
v_add_f32 v16, v52, v54
v_mov_b32 v53, v16
s_nop 1
v_permlane32_swap_b32 v16, v53
v_add_f32 v16, v16, v53
v_mov_b32 v53, v16
s_nop 1
v_permlane16_swap_b32 v16, v53
v_add_f32 v16, v16, v53
v_mov_b32 v17, s37
s_mov_b64 exec, 0xf
buffer_store_dwordx4 v[16:19], v6, s[24:27], s74 offen sc1
s_mov_b64 exec, -1
s_call_b64 s[72:73], L_xiss
s_waitcnt vmcnt(17)
s_barrier
s_waitcnt vmcnt(9)
s_call_b64 s[72:73], L_pk0
s_call_b64 s[72:73], L_xiss
s_waitcnt vmcnt(8)
s_barrier
s_call_b64 s[72:73], L_pk1
s_add_u32 s67, s67, 57344
s_call_b64 s[72:73], L_xiss
s_mov_b32 s84, s48
s_and_b32 s85, s49, 0xffff
s_mov_b32 s86, 14680064
s_mov_b32 s87, 0x00020000
s_lshl_b32 s28, s12, 7
s_mul_i32 s29, s50, 127
s_add_u32 s28, s28, s29
s_mul_i32 s28, s28, 7168
s_mul_i32 s29, s13, 448
s_add_u32 s28, s28, s29
s_mov_b64 exec, 0xf
buffer_store_dwordx4 v[64:67], v6, s[84:87], s28 offen sc1 nt
s_mov_b64 exec, -1
s_waitcnt vmcnt(11)
s_barrier
s_call_b64 s[72:73], L_xiss
s_lshl_b32 s75, s12, 11
s_lshl_b32 s29, s50, 10
s_add_u32 s75, s75, s29
s_add_u32 s75, s75, 5242880
buffer_load_dwordx2 v[62:63], v6, s[24:27], s75 offen sc1
s_waitcnt vmcnt(10)
s_barrier
s_waitcnt vmcnt(0)
s_call_b64 s[72:73], L_rchk
s_call_b64 s[72:73], L_xiss
s_barrier
s_call_b64 s[72:73], L_xiss
s_waitcnt vmcnt(8)
s_barrier
s_call_b64 s[72:73], L_xiss
s_waitcnt vmcnt(8)
s_barrier
s_waitcnt vmcnt(0)
L_xs_end:
s_barrier
s_or_b32 s28, s13, s50
s_cbranch_scc1 L_lepi
s_lshl_b32 s28, s12, 7
s_add_u32 s28, s28, 5277696
v_mov_b32 v20, 0
v_mov_b32 v21, s37
s_mov_b64 exec, 1
buffer_store_dword v21, v20, s[24:27], s28 offen sc1
s_mov_b64 exec, -1
s_branch L_lepi
L_wload:
s_sub_u32 s50, s14, 4
s_mul_i32 s28, s13, 229376
s_mul_i32 s29, s50, 7168
s_add_u32 s28, s28, s29
s_add_u32 s31, s28, 1048576
s_mov_b32 s41, s31
s_add_u32 s18, s29, 16384
v_lshlrev_b32 v14, 4, v1
v_add_u32 v15, 4096, v14
v_add_u32 v13, s18, v14
s_mov_b32 s32, 0
s_mov_b32 s42, 0
s_mov_b32 s43, 0xf0f0f0f0
s_mov_b32 s40, 0
s_waitcnt lgkmcnt(0)
s_lshl_b32 s28, s13, 7
s_add_u32 s28, s28, 5275648
s_load_dword s36, s[8:9], s28
s_load_dwordx2 s[48:49], s[0:1], 32
s_mov_b32 s24, s8
s_and_b32 s25, s9, 0xffff
s_mov_b32 s26, 9961472
s_mov_b32 s27, 0x00020000
s_mov_b64 exec, 0
s_cmp_eq_u32 s50, 0
s_cbranch_scc1 L_warm0
s_call_b64 s[72:73], L_wcheck
s_branch L_warm1
L_warm0:
s_call_b64 s[72:73], L_pad1
s_call_b64 s[72:73], L_pad2
L_warm1:
s_mov_b64 exec, -1
s_mov_b32 s41, s31
s_mov_b32 s42, 0
s_waitcnt lgkmcnt(0)
s_bfe_u32 s36, s36, 0x10007
s_xor_b32 s36, s36, 1
s_mul_i32 s38, s36, 0x80808080
v_mov_b32 v11, s38
s_barrier
s_mov_b32 s33, 0
s_add_u32 m0, s18, s32
s_nop 0
buffer_load_dwordx4 v14, s[24:27], s31 offen offset:0 sc1 lds
buffer_load_dwordx4 v14, s[24:27], s31 offen offset:1024 sc1 lds
buffer_load_dwordx4 v14, s[24:27], s31 offen offset:2048 sc1 lds
buffer_load_dwordx4 v14, s[24:27], s31 offen offset:3072 sc1 lds
s_add_u32 m0, m0, 4096
s_nop 0
buffer_load_dwordx4 v15, s[24:27], s31 offen offset:0 sc1 lds
buffer_load_dwordx4 v15, s[24:27], s31 offen offset:1024 sc1 lds
buffer_load_dwordx4 v15, s[24:27], s31 offen offset:2048 sc1 lds
s_add_u32 s32, s32, 30720
s_cmp_eq_u32 s32, 122880
s_cselect_b32 s32, 0, s32
s_add_u32 s31, s31, 14336
s_branch L_w_in
L_w:
s_barrier
L_w_in:
s_add_u32 m0, s18, s32
s_nop 0
buffer_load_dwordx4 v14, s[24:27], s31 offen offset:0 sc1 lds
buffer_load_dwordx4 v14, s[24:27], s31 offen offset:1024 sc1 lds
buffer_load_dwordx4 v14, s[24:27], s31 offen offset:2048 sc1 lds
buffer_load_dwordx4 v14, s[24:27], s31 offen offset:3072 sc1 lds
s_add_u32 m0, m0, 4096
s_nop 0
buffer_load_dwordx4 v15, s[24:27], s31 offen offset:0 sc1 lds
buffer_load_dwordx4 v15, s[24:27], s31 offen offset:1024 sc1 lds
buffer_load_dwordx4 v15, s[24:27], s31 offen offset:2048 sc1 lds
s_add_u32 s32, s32, 30720
s_cmp_eq_u32 s32, 122880
s_cselect_b32 s32, 0, s32
s_add_u32 s31, s31, 14336
s_cmp_lt_u32 s33, 13
s_cbranch_scc1 L_w_np
s_setprio 1
L_w_np:
s_waitcnt vmcnt(7)
s_call_b64 s[72:73], L_wcheck
s_add_u32 s33, s33, 1
s_cmp_lt_u32 s33, 15
s_cbranch_scc1 L_w
s_barrier
s_waitcnt vmcnt(0)
s_call_b64 s[72:73], L_wcheck
s_barrier
s_or_b32 s28, s12, s50
s_cbranch_scc1 L_lepi
s_lshl_b32 s28, s13, 7
s_add_u32 s28, s28, 5275648
v_mov_b32 v20, 0
s_mov_b64 exec, 1
buffer_store_dword v11, v20, s[24:27], s28 offen sc1
s_mov_b64 exec, -1
L_lepi:
s_setprio 0
s_mov_b32 s20, s48
s_and_b32 s21, s49, 0xffff
s_mov_b32 s22, 14680064
s_mov_b32 s23, 0x00020000
s_mov_b32 s18, s82
s_add_u32 s19, s18, 28672
s_mov_b32 s33, 0
L_st0:
s_barrier
ds_read_b128 v[16:19], v69 offset:0
ds_read_b128 v[20:23], v69 offset:1088
v_add_u32 v69, 4352, v69
s_add_u32 s33, s33, 1
s_waitcnt lgkmcnt(1)
buffer_store_dwordx4 v[16:19], v70, s[20:23], s18 offen offset:0 sc1 nt
s_waitcnt lgkmcnt(0)
buffer_store_dwordx4 v[20:23], v70, s[20:23], s19 offen offset:0 sc1 nt
s_add_u32 s18, s18, 114688
s_add_u32 s19, s19, 114688
s_cmp_lt_u32 s33, 4
s_cbranch_scc1 L_st0
s_sub_u32 s18, s18, 458752
s_sub_u32 s19, s19, 458752
s_mov_b32 s33, 0
L_st1:
s_barrier
ds_read_b128 v[16:19], v68 offset:0
ds_read_b128 v[20:23], v68 offset:832
ds_read_b128 v[24:27], v68 offset:3328
ds_read_b128 v[28:31], v68 offset:4160
v_add_u32 v68, 6656, v68
s_add_u32 s33, s33, 1
s_waitcnt lgkmcnt(3)
buffer_store_dwordx4 v[16:19], v71, s[20:23], s18 offen offset:256 sc1 nt
s_waitcnt lgkmcnt(2)
buffer_store_dwordx4 v[20:23], v71, s[20:23], s19 offen offset:256 sc1 nt
s_add_u32 s18, s18, 114688
s_add_u32 s19, s19, 114688
s_waitcnt lgkmcnt(1)
buffer_store_dwordx4 v[24:27], v71, s[20:23], s18 offen offset:256 sc1 nt
s_waitcnt lgkmcnt(0)
buffer_store_dwordx4 v[28:31], v71, s[20:23], s19 offen offset:256 sc1 nt
s_add_u32 s18, s18, 114688
s_add_u32 s19, s19, 114688
s_cmp_lt_u32 s33, 2
s_cbranch_scc1 L_st1
s_endpgm
.p2align 6
L_wretry:
s_add_u32 m0, s18, s42
s_nop 0
buffer_load_dwordx4 v14, s[24:27], s41 offen offset:0 sc1 lds
buffer_load_dwordx4 v14, s[24:27], s41 offen offset:1024 sc1 lds
buffer_load_dwordx4 v14, s[24:27], s41 offen offset:2048 sc1 lds
buffer_load_dwordx4 v14, s[24:27], s41 offen offset:3072 sc1 lds
s_add_u32 m0, m0, 4096
s_nop 0
buffer_load_dwordx4 v15, s[24:27], s41 offen offset:0 sc1 lds
buffer_load_dwordx4 v15, s[24:27], s41 offen offset:1024 sc1 lds
buffer_load_dwordx4 v15, s[24:27], s41 offen offset:2048 sc1 lds
s_waitcnt vmcnt(0)
L_wcheck:
v_add_u32 v12, s42, v13
ds_read2st64_b32 v[16:17], v12 offset0:0 offset1:4
ds_read2st64_b32 v[18:19], v12 offset0:8 offset1:12
ds_read2st64_b32 v[20:21], v12 offset0:16 offset1:20
ds_read_b32 v22, v12 offset:6144
s_waitcnt lgkmcnt(3)
v_bitop3_b32 v16, v16, v17, v11 bitop3:0x7e
s_waitcnt lgkmcnt(2)
v_bitop3_b32 v18, v18, v19, v11 bitop3:0x7e
s_waitcnt lgkmcnt(1)
v_bitop3_b32 v20, v20, v21, v11 bitop3:0x7e
v_or3_b32 v16, v16, v18, v20
s_waitcnt lgkmcnt(0)
v_bitop3_b32 v16, v16, v22, v11 bitop3:0xf6
v_and_b32 v16, s43, v16
v_cmp_ne_u32 vcc, 0, v16
s_cmp_eq_u64 vcc, 0
s_cbranch_scc1 L_wcheck_ok
s_add_u32 s40, s40, 1
s_cmp_lt_u32 s40, 100000
s_cbranch_scc1 L_wretry
L_wcheck_ok:
s_add_u32 s42, s42, 30720
s_cmp_eq_u32 s42, 122880
s_cselect_b32 s42, 0, s42
s_add_u32 s41, s41, 14336
s_setpc_b64 s[72:73]
L_rretry:
buffer_load_dwordx2 v[62:63], v6, s[24:27], s75 offen sc1
s_waitcnt vmcnt(0)
L_rchk:
v_cmp_ne_u32 vcc, s37, v63
v_and_b32 v8, 15, v1
v_lshlrev_b32 v8, 4, v8
v_lshrrev_b32 v9, 4, v1
s_cmp_eq_u64 vcc, 0
s_cbranch_scc1 L_rchk_ok
s_add_u32 s40, s40, 1
s_cmp_lt_u32 s40, 100000
s_cbranch_scc1 L_rretry
L_rchk_ok:
v_lshl_add_u32 v8, v9, 2, v8
s_lshl_b32 s29, s50, 8
s_add_u32 s29, s29, 122880
v_add_u32 v8, s29, v8
ds_write_b32 v8, v62
s_waitcnt lgkmcnt(0)
s_setpc_b64 s[72:73]
L_padret:
s_setpc_b64 s[72:73]
L_last:
.section .rodata,"a"
.p2align 6
.amdhsa_kernel standalone__w4a16_gemm_dequant__prompt_kernel
  .amdhsa_next_free_vgpr 256
  .amdhsa_next_free_sgpr 96
  .amdhsa_accum_offset 256
  .amdhsa_group_segment_fixed_size 0
  .amdhsa_kernarg_size 56
  .amdhsa_user_sgpr_count 2
  .amdhsa_user_sgpr_kernarg_segment_ptr 1
  .amdhsa_system_sgpr_workgroup_id_x 1
  .amdhsa_float_denorm_mode_32 3
  .amdhsa_float_denorm_mode_16_64 3
.end_amdhsa_kernel
```
